```python
import torch

def _softmax(x, axis=-1):
    return torch.softmax(x, dim=axis)
def _gelu(x):
    return torch.nn.functional.gelu(x, approximate="tanh")
def _silu(x):
    return torch.nn.functional.silu(x)
def _sigmoid(x):
    return torch.sigmoid(x)
def _layernorm(x, axis=-1, eps=1e-5):
    m = x.mean(dim=axis, keepdim=True)
    v = x.var(dim=axis, keepdim=True, unbiased=False)
    return (x - m) / torch.sqrt(v + eps)
def _scatter_add(tgt, idx, src, axis=0):
    return tgt.clone().index_add_(axis, idx, src)
def _segment_sum(src, seg, n):
    out = torch.zeros((n,) + src.shape[1:], dtype=src.dtype)
    return out.index_add_(0, seg, src)
def _pad(x, pw):
    flat = tuple(v for pair in reversed(pw) for v in pair)
    return torch.nn.functional.pad(x, flat)

kernel_name = 'concat_heads__ssm_conv_s4__grouped_kv_mqa__prompt'

def setup_inputs():

    _w = (lambda a: (lambda t: t.to(torch.bfloat16) if t.is_floating_point() else t)(torch.as_tensor(a)))
    def _A_setup():
        B, L, D, N = 1, 2048, 512, 128
        A_re = -(lambda _x: torch.exp(torch.as_tensor(_x)))((lambda *s: torch.randn(*s, dtype=torch.bfloat16) * 3.2)(D, N))
        A_im = torch.pi * (lambda *s: torch.randn(*s, dtype=torch.bfloat16) * 0.05)(D, N)
        B_re = (lambda *s: torch.randn(*s, dtype=torch.bfloat16) * 0.1)(D, N)
        B_im = (lambda *s: torch.randn(*s, dtype=torch.bfloat16) * 0.1)(D, N)
        C_re = (lambda *s: torch.randn(*s, dtype=torch.bfloat16) * 0.1)(D, N)
        C_im = (lambda *s: torch.randn(*s, dtype=torch.bfloat16) * 0.1)(D, N)
        log_dt = (lambda *s: torch.randn(*s, dtype=torch.bfloat16) * 0.05)(D) * 0.5 - 4.0
        Dskip = (lambda *s: torch.randn(*s, dtype=torch.bfloat16) * 0.05)(D)
        return {
            "u": _w((lambda *s: torch.randn(*s, dtype=torch.bfloat16) * 0.05)(B, L, D)),
            "A_re": _w(A_re),
            "A_im": _w(A_im),
            "B_re": _w(B_re),
            "B_im": _w(B_im),
            "C_re": _w(C_re),
            "C_im": _w(C_im),
            "log_dt": _w(log_dt),
            "Dskip": _w(Dskip),
        }
    _A_in = _A_setup()

    def _B_setup():
        B, S, D, H = 1, 2048, 512, 32
        Dh = D // H
        return {
            "x": _w((lambda *s: torch.randn(*s, dtype=torch.bfloat16) * 0.05)(B, S, D)),
            "wq": _w((lambda *s: torch.randn(*s, dtype=torch.bfloat16) * 0.8)(D, H * Dh)),
            "wk": _w((lambda *s: torch.randn(*s, dtype=torch.bfloat16) * 0.8)(D, Dh)),
            "wv": _w((lambda *s: torch.randn(*s, dtype=torch.bfloat16) * 0.05)(D, Dh)),
            "wo": _w((lambda *s: torch.randn(*s, dtype=torch.bfloat16) * 0.05)(H * Dh, D)),
        }
    _B_in = _B_setup()

    return {
        "A_u": _A_in["u"],
        "A_A_re": _A_in["A_re"],
        "A_A_im": _A_in["A_im"],
        "A_B_re": _A_in["B_re"],
        "A_B_im": _A_in["B_im"],
        "A_C_re": _A_in["C_re"],
        "A_C_im": _A_in["C_im"],
        "A_log_dt": _A_in["log_dt"],
        "A_Dskip": _A_in["Dskip"],
        "B_x": _B_in["x"],
        "B_wq": _B_in["wq"],
        "B_wk": _B_in["wk"],
        "B_wv": _B_in["wv"],
        "B_wo": _B_in["wo"],
    }

def reference(A_u, A_A_re, A_A_im, A_B_re, A_B_im, A_C_re, A_C_im, A_log_dt, A_Dskip, B_x, B_wq, B_wk, B_wv, B_wo):
    def _A_ref(u, A_re, A_im, B_re, B_im, C_re, C_im, log_dt, Dskip):
        Bsz, L, D = u.shape
        dt = torch.exp(log_dt)[:, None]
        A = A_re + 1j * A_im
        Bc = B_re + 1j * B_im
        Cc = C_re + 1j * C_im
        logdA = dt * A
        dB = dt * Bc
        l = (lambda x, dt: x.to(dt))(torch.arange(L), A_re.dtype)
        P = torch.exp(logdA[:, :, None] * l[None, None, :])
        K = torch.einsum("dn,dnl,dn->dl", Cc, P, dB).real
        L2 = 2 * L
        Kp = _pad(K, ((0, 0), (0, L)))
        up = (lambda x, *d: x.permute(*d))(u, 0, 2, 1)
        up = _pad(up, ((0, 0), (0, 0), (0, L)))
        Kf = (lambda x, axes=(-2,-1): torch.fft.rfft2(x.float(), dim=axes))(Kp[:, None, :], axes=(-2, -1))
        Uf = (lambda x, axes=(-2,-1): torch.fft.rfft2(x.float(), dim=axes))(up[:, :, None, :], axes=(-2, -1))
        Yf = Uf * Kf[None, :, :, :]
        y = (lambda x, s, axes=(-2,-1): torch.fft.irfft2(x, s=s, dim=axes).to(torch.bfloat16))(Yf, (1, L2), axes=(-2, -1))[:, :, 0, :L]
        y = (lambda x, *d: x.permute(*d))(y, 0, 2, 1) + u * Dskip[None, None, :]
        return y

    def _B_ref(x, wq, wk, wv, wo):
        B, S, D = x.shape
        H = 32
        Dh = D // H
        q = (lambda x, *d: x.permute(*d))((x @ wq).reshape(B, S, H, Dh), 0, 2, 1, 3)
        k = x @ wk
        v = x @ wv
        scores = torch.einsum("bhqd,bkd->bhqk", q, k) * (Dh ** -0.5)
        p = _softmax(scores, axis=-1)
        o = torch.einsum("bhqk,bkd->bhqd", p, v)
        return (lambda x, *d: x.permute(*d))(o, 0, 2, 1, 3).reshape(B, S, H * Dh) @ wo

    a = _A_ref(A_u, A_A_re, A_A_im, A_B_re, A_B_im, A_C_re, A_C_im, A_log_dt, A_Dskip)
    b = _B_ref(B_x, B_wq, B_wk, B_wv, B_wo)
    return torch.concatenate([a, b], axis=-1)
```

```asm
; @launch grid=(256,1,1) block=(512,1,1) lds=156160
.amdgcn_target "amdgcn-amd-amdhsa--gfx950"
.text
.globl concat_heads__ssm_conv_s4__grouped_kv_mqa__prompt_kernel
.p2align 8
.type concat_heads__ssm_conv_s4__grouped_kv_mqa__prompt_kernel,@function
concat_heads__ssm_conv_s4__grouped_kv_mqa__prompt_kernel:
    s_cmp_ge_u32 s2, 256
    s_cbranch_scc1 L_exit
    s_load_dwordx16 s[32:47], s[0:1], 64
    s_load_dwordx2 s[48:49], s[0:1], 128
    s_load_dwordx16 s[16:31], s[0:1], 0
    v_lshrrev_b32 v2, 6, v0
    v_and_b32 v1, 63, v0
    v_readfirstlane_b32 s3, v2
    s_and_b32 s4, s2, 7
    s_lshr_b32 s5, s2, 3
    s_lshr_b32 s6, s5, 3
    s_lshl2_add_u32 s6, s4, s6
    s_and_b32 s7, s5, 7
    s_lshl_b32 s8, s4, 5
    s_add_u32 s8, s8, s5
    s_mov_b32 s63, 0x40000
    v_and_b32 v3, 15, v1
    v_lshrrev_b32 v4, 4, v1
    v_lshrrev_b32 v5, 5, v1
    v_lshlrev_b32 v6, 4, v1
    v_mov_b32 v9, 1
    v_mov_b32 v10, 155904
    v_mov_b32 v7, 0
    v_lshl_add_u32 v8, v1, 2, v10
    ds_write_b32 v8, v7
    s_add_u32 s59, s6, s7
    s_and_b32 s59, s59, 3
    s_cmp_gt_u32 s3, 3
    s_cbranch_scc1 L_nocpf
    s_getpc_b64 s[10:11]
L_pc:
    s_lshl2_add_u32 s12, s5, s3
    s_and_b32 s12, s12, 31
    s_min_u32 s12, s12, (L_codeend - L_pc) / 1024 - 1
    s_lshl_b32 s12, s12, 10
    v_add_u32 v12, s12, v6
    global_load_dwordx4 v[60:63], v12, s[10:11]
L_nocpf:
    v_add_u32 v20, 0, v4
    v_xor_b32 v21, v20, v3
    v_lshlrev_b32 v21, 4, v21
    v_lshl_add_u32 v56, v20, 10, v21
    v_add_u32 v20, 4, v4
    v_xor_b32 v21, v20, v3
    v_lshlrev_b32 v21, 4, v21
    v_lshl_add_u32 v57, v20, 10, v21
    v_subrev_u32 v57, 1024, v57
    v_add_u32 v20, 8, v4
    v_xor_b32 v21, v20, v3
    v_lshlrev_b32 v21, 4, v21
    v_lshl_add_u32 v58, v20, 10, v21
    v_subrev_u32 v58, 2048, v58
    v_add_u32 v20, 12, v4
    v_xor_b32 v21, v20, v3
    v_lshlrev_b32 v21, 4, v21
    v_lshl_add_u32 v59, v20, 10, v21
    v_subrev_u32 v59, 3072, v59
    s_cmp_lg_u32 s3, 4
    s_cbranch_scc1 L_not4
    s_setprio 3
    s_and_b32 s60, s7, 3
    s_lshl2_add_u32 s60, s6, s60
    s_lshr_b32 s61, s7, 2
    s_lshl_b32 s56, s60, 14
    s_waitcnt lgkmcnt(0)
    s_load_dwordx2 s[50:51], s[48:49], 131072
    s_cmp_eq_u32 s61, 0
    s_cselect_b32 s12, s38, s40
    s_cselect_b32 s13, s39, s41
    s_mov_b32 s52, s34
    s_and_b32 s53, s35, 0xffff
    s_mov_b32 s54, 2097152
    s_mov_b32 s55, 0x20000
    s_mov_b32 m0, 98304
    s_lshl_b32 s10, s59, 8
    s_add_u32 s10, s10, s56
    buffer_load_dwordx4 v56, s[52:55], s10 offen offset:0 lds
    buffer_load_dwordx4 v57, s[52:55], s10 offen offset:1024 lds
    buffer_load_dwordx4 v58, s[52:55], s10 offen offset:2048 lds
    buffer_load_dwordx4 v59, s[52:55], s10 offen offset:3072 lds
    s_lshl_b32 s10, s59, 12
    v_add_u32 v24, s10, v6
    s_mov_b32 m0, 114688
    s_add_u32 s59, s59, 1
    s_and_b32 s59, s59, 3
    global_load_lds_dwordx4 v24, s[12:13] offset:0
    global_load_lds_dwordx4 v24, s[12:13] offset:1024
    global_load_lds_dwordx4 v24, s[12:13] offset:2048
    global_load_lds_dwordx4 v24, s[12:13] offset:3072
    s_mov_b32 m0, 102400
    s_lshl_b32 s10, s59, 8
    s_add_u32 s10, s10, s56
    buffer_load_dwordx4 v56, s[52:55], s10 offen offset:0 lds
    buffer_load_dwordx4 v57, s[52:55], s10 offen offset:1024 lds
    buffer_load_dwordx4 v58, s[52:55], s10 offen offset:2048 lds
    buffer_load_dwordx4 v59, s[52:55], s10 offen offset:3072 lds
    s_lshl_b32 s10, s59, 12
    v_add_u32 v24, s10, v6
    s_mov_b32 m0, 118784
    s_add_u32 s59, s59, 1
    s_and_b32 s59, s59, 3
    global_load_lds_dwordx4 v24, s[12:13] offset:0
    global_load_lds_dwordx4 v24, s[12:13] offset:1024
    global_load_lds_dwordx4 v24, s[12:13] offset:2048
    global_load_lds_dwordx4 v24, s[12:13] offset:3072
    s_mov_b32 m0, 106496
    s_lshl_b32 s10, s59, 8
    s_add_u32 s10, s10, s56
    buffer_load_dwordx4 v56, s[52:55], s10 offen offset:0 lds
    buffer_load_dwordx4 v57, s[52:55], s10 offen offset:1024 lds
    buffer_load_dwordx4 v58, s[52:55], s10 offen offset:2048 lds
    buffer_load_dwordx4 v59, s[52:55], s10 offen offset:3072 lds
    s_lshl_b32 s10, s59, 12
    v_add_u32 v24, s10, v6
    s_mov_b32 m0, 122880
    s_add_u32 s59, s59, 1
    s_and_b32 s59, s59, 3
    global_load_lds_dwordx4 v24, s[12:13] offset:0
    global_load_lds_dwordx4 v24, s[12:13] offset:1024
    global_load_lds_dwordx4 v24, s[12:13] offset:2048
    global_load_lds_dwordx4 v24, s[12:13] offset:3072
    s_mov_b32 m0, 110592
    s_lshl_b32 s10, s59, 8
    s_add_u32 s10, s10, s56
    buffer_load_dwordx4 v56, s[52:55], s10 offen offset:0 lds
    buffer_load_dwordx4 v57, s[52:55], s10 offen offset:1024 lds
    buffer_load_dwordx4 v58, s[52:55], s10 offen offset:2048 lds
    buffer_load_dwordx4 v59, s[52:55], s10 offen offset:3072 lds
    s_lshl_b32 s10, s59, 12
    v_add_u32 v24, s10, v6
    s_mov_b32 m0, 126976
    s_add_u32 s59, s59, 1
    s_and_b32 s59, s59, 3
    global_load_lds_dwordx4 v24, s[12:13] offset:0
    global_load_lds_dwordx4 v24, s[12:13] offset:1024
    global_load_lds_dwordx4 v24, s[12:13] offset:2048
    global_load_lds_dwordx4 v24, s[12:13] offset:3072
    s_barrier
    s_branch L_kv2
L_not4:
    s_cmp_eq_u32 s3, 7
    s_cbranch_scc1 L_loader
    s_and_b32 s14, s3, 1
    s_lshl1_add_u32 s10, s8, s14
    s_lshl_b32 s10, s10, 8
    v_lshl_add_u32 v7, v1, 2, s10
    s_lshl_b32 s10, s8, 2
    s_waitcnt lgkmcnt(0)
    s_load_dwordx2 s[50:51], s[48:49], 131072
    s_cmp_lt_u32 s3, 4
    s_cbranch_scc1 L_abar
    s_setprio 1
    s_load_dword s60, s[30:31], s10
    global_load_dword v192, v7, s[18:19]
    global_load_dword v193, v7, s[20:21]
    global_load_dword v194, v7, s[22:23]
    global_load_dword v195, v7, s[24:25]
    global_load_dword v196, v7, s[26:27]
    global_load_dword v197, v7, s[28:29]
    s_barrier
    s_branch L_kgen
L_abar:
    s_barrier
    s_branch L_attn
L_loader:
    v_lshrrev_b32 v11, 3, v1
    v_and_b32 v12, 1, v4
    v_lshlrev_b32 v12, 2, v12
    v_and_b32 v13, 7, v1
    v_xor_b32 v12, v12, v13
    v_lshlrev_b32 v12, 4, v12
    v_lshl_add_u32 v222, v11, 10, v12
    v_add_u32 v223, 7168, v222
    v_add_u32 v224, 14336, v222
    v_add_u32 v225, 21504, v222
    s_lshl_b32 s61, s7, 7
    s_lshl_b32 s57, s6, 16
    s_waitcnt lgkmcnt(0)
    s_load_dwordx2 s[50:51], s[48:49], 131072
    s_mov_b32 s52, s34
    s_and_b32 s53, s35, 0xffff
    s_mov_b32 s54, 2097152
    s_mov_b32 s55, 0x20000
    s_mov_b32 s12, s36
    s_and_b32 s13, s37, 0xffff
    s_mov_b32 s14, 524288
    s_mov_b32 s15, 0x20000
    s_setprio 2
    s_barrier
    s_add_u32 s60, s59, 0
    s_and_b32 s60, s60, 3
    s_lshl_b32 s56, s60, 8
    s_add_u32 s56, s56, s57
    s_lshl_b32 s60, s60, 17
    s_add_u32 s60, s60, s61
    s_mov_b32 m0, 16384
    s_nop 0
    buffer_load_dwordx4 v222, s[12:15], s60 offen offset:0 lds
    buffer_load_dwordx4 v223, s[12:15], s60 offen offset:1024 lds
    buffer_load_dwordx4 v224, s[12:15], s60 offen offset:2048 lds
    buffer_load_dwordx4 v225, s[12:15], s60 offen offset:3072 lds
    s_mov_b32 m0, 20480
    s_add_u32 s60, s60, 32768
    buffer_load_dwordx4 v222, s[12:15], s60 offen offset:0 lds
    buffer_load_dwordx4 v223, s[12:15], s60 offen offset:1024 lds
    buffer_load_dwordx4 v224, s[12:15], s60 offen offset:2048 lds
    buffer_load_dwordx4 v225, s[12:15], s60 offen offset:3072 lds
    s_mov_b32 m0, 24576
    s_add_u32 s60, s60, 32768
    buffer_load_dwordx4 v222, s[12:15], s60 offen offset:0 lds
    buffer_load_dwordx4 v223, s[12:15], s60 offen offset:1024 lds
    buffer_load_dwordx4 v224, s[12:15], s60 offen offset:2048 lds
    buffer_load_dwordx4 v225, s[12:15], s60 offen offset:3072 lds
    s_mov_b32 m0, 28672
    s_add_u32 s60, s60, 32768
    buffer_load_dwordx4 v222, s[12:15], s60 offen offset:0 lds
    buffer_load_dwordx4 v223, s[12:15], s60 offen offset:1024 lds
    buffer_load_dwordx4 v224, s[12:15], s60 offen offset:2048 lds
    buffer_load_dwordx4 v225, s[12:15], s60 offen offset:3072 lds
    s_mov_b32 m0, 0
    s_nop 0
    buffer_load_dwordx4 v56, s[52:55], s56 offen offset:0 lds
    buffer_load_dwordx4 v57, s[52:55], s56 offen offset:1024 lds
    buffer_load_dwordx4 v58, s[52:55], s56 offen offset:2048 lds
    buffer_load_dwordx4 v59, s[52:55], s56 offen offset:3072 lds
    s_mov_b32 m0, 4096
    s_add_u32 s56, s56, 16384
    buffer_load_dwordx4 v56, s[52:55], s56 offen offset:0 lds
    buffer_load_dwordx4 v57, s[52:55], s56 offen offset:1024 lds
    buffer_load_dwordx4 v58, s[52:55], s56 offen offset:2048 lds
    buffer_load_dwordx4 v59, s[52:55], s56 offen offset:3072 lds
    s_mov_b32 m0, 8192
    s_add_u32 s56, s56, 16384
    buffer_load_dwordx4 v56, s[52:55], s56 offen offset:0 lds
    buffer_load_dwordx4 v57, s[52:55], s56 offen offset:1024 lds
    buffer_load_dwordx4 v58, s[52:55], s56 offen offset:2048 lds
    buffer_load_dwordx4 v59, s[52:55], s56 offen offset:3072 lds
    s_mov_b32 m0, 12288
    s_add_u32 s56, s56, 16384
    buffer_load_dwordx4 v56, s[52:55], s56 offen offset:0 lds
    buffer_load_dwordx4 v57, s[52:55], s56 offen offset:1024 lds
    buffer_load_dwordx4 v58, s[52:55], s56 offen offset:2048 lds
    buffer_load_dwordx4 v59, s[52:55], s56 offen offset:3072 lds
    s_add_u32 s60, s59, 1
    s_and_b32 s60, s60, 3
    s_lshl_b32 s56, s60, 8
    s_add_u32 s56, s56, s57
    s_lshl_b32 s60, s60, 17
    s_add_u32 s60, s60, s61
    s_mov_b32 m0, 49152
    s_nop 0
    buffer_load_dwordx4 v222, s[12:15], s60 offen offset:0 lds
    buffer_load_dwordx4 v223, s[12:15], s60 offen offset:1024 lds
    buffer_load_dwordx4 v224, s[12:15], s60 offen offset:2048 lds
    buffer_load_dwordx4 v225, s[12:15], s60 offen offset:3072 lds
    s_mov_b32 m0, 53248
    s_add_u32 s60, s60, 32768
    buffer_load_dwordx4 v222, s[12:15], s60 offen offset:0 lds
    buffer_load_dwordx4 v223, s[12:15], s60 offen offset:1024 lds
    buffer_load_dwordx4 v224, s[12:15], s60 offen offset:2048 lds
    buffer_load_dwordx4 v225, s[12:15], s60 offen offset:3072 lds
    s_mov_b32 m0, 57344
    s_add_u32 s60, s60, 32768
    buffer_load_dwordx4 v222, s[12:15], s60 offen offset:0 lds
    buffer_load_dwordx4 v223, s[12:15], s60 offen offset:1024 lds
    buffer_load_dwordx4 v224, s[12:15], s60 offen offset:2048 lds
    buffer_load_dwordx4 v225, s[12:15], s60 offen offset:3072 lds
    s_mov_b32 m0, 61440
    s_add_u32 s60, s60, 32768
    buffer_load_dwordx4 v222, s[12:15], s60 offen offset:0 lds
    buffer_load_dwordx4 v223, s[12:15], s60 offen offset:1024 lds
    buffer_load_dwordx4 v224, s[12:15], s60 offen offset:2048 lds
    buffer_load_dwordx4 v225, s[12:15], s60 offen offset:3072 lds
    s_mov_b32 m0, 32768
    s_nop 0
    buffer_load_dwordx4 v56, s[52:55], s56 offen offset:0 lds
    buffer_load_dwordx4 v57, s[52:55], s56 offen offset:1024 lds
    buffer_load_dwordx4 v58, s[52:55], s56 offen offset:2048 lds
    buffer_load_dwordx4 v59, s[52:55], s56 offen offset:3072 lds
    s_waitcnt vmcnt(48)
    s_mov_b32 m0, 36864
    s_add_u32 s56, s56, 16384
    buffer_load_dwordx4 v56, s[52:55], s56 offen offset:0 lds
    buffer_load_dwordx4 v57, s[52:55], s56 offen offset:1024 lds
    buffer_load_dwordx4 v58, s[52:55], s56 offen offset:2048 lds
    buffer_load_dwordx4 v59, s[52:55], s56 offen offset:3072 lds
    s_waitcnt vmcnt(48)
    s_mov_b32 m0, 40960
    s_add_u32 s56, s56, 16384
    buffer_load_dwordx4 v56, s[52:55], s56 offen offset:0 lds
    buffer_load_dwordx4 v57, s[52:55], s56 offen offset:1024 lds
    buffer_load_dwordx4 v58, s[52:55], s56 offen offset:2048 lds
    buffer_load_dwordx4 v59, s[52:55], s56 offen offset:3072 lds
    s_waitcnt vmcnt(48)
    s_mov_b32 m0, 45056
    s_add_u32 s56, s56, 16384
    buffer_load_dwordx4 v56, s[52:55], s56 offen offset:0 lds
    buffer_load_dwordx4 v57, s[52:55], s56 offen offset:1024 lds
    buffer_load_dwordx4 v58, s[52:55], s56 offen offset:2048 lds
    buffer_load_dwordx4 v59, s[52:55], s56 offen offset:3072 lds
    s_waitcnt vmcnt(48)
    s_add_u32 s60, s59, 2
    s_and_b32 s60, s60, 3
    s_lshl_b32 s56, s60, 8
    s_add_u32 s56, s56, s57
    s_lshl_b32 s60, s60, 17
    s_add_u32 s60, s60, s61
    s_mov_b32 m0, 81920
    s_nop 0
    buffer_load_dwordx4 v222, s[12:15], s60 offen offset:0 lds
    buffer_load_dwordx4 v223, s[12:15], s60 offen offset:1024 lds
    buffer_load_dwordx4 v224, s[12:15], s60 offen offset:2048 lds
    buffer_load_dwordx4 v225, s[12:15], s60 offen offset:3072 lds
    s_waitcnt vmcnt(48)
    s_mov_b32 m0, 86016
    s_add_u32 s60, s60, 32768
    buffer_load_dwordx4 v222, s[12:15], s60 offen offset:0 lds
    buffer_load_dwordx4 v223, s[12:15], s60 offen offset:1024 lds
    buffer_load_dwordx4 v224, s[12:15], s60 offen offset:2048 lds
    buffer_load_dwordx4 v225, s[12:15], s60 offen offset:3072 lds
    s_waitcnt vmcnt(48)
    s_mov_b32 m0, 90112
    s_add_u32 s60, s60, 32768
    buffer_load_dwordx4 v222, s[12:15], s60 offen offset:0 lds
    buffer_load_dwordx4 v223, s[12:15], s60 offen offset:1024 lds
    buffer_load_dwordx4 v224, s[12:15], s60 offen offset:2048 lds
    buffer_load_dwordx4 v225, s[12:15], s60 offen offset:3072 lds
    s_waitcnt vmcnt(48)
    s_mov_b32 m0, 94208
    s_add_u32 s60, s60, 32768
    buffer_load_dwordx4 v222, s[12:15], s60 offen offset:0 lds
    buffer_load_dwordx4 v223, s[12:15], s60 offen offset:1024 lds
    buffer_load_dwordx4 v224, s[12:15], s60 offen offset:2048 lds
    buffer_load_dwordx4 v225, s[12:15], s60 offen offset:3072 lds
    s_waitcnt vmcnt(48)
    s_mov_b64 exec, 1
    ds_add_u32 v10, v9 offset:0
    s_mov_b64 exec, -1
    s_mov_b32 m0, 65536
    s_nop 0
    buffer_load_dwordx4 v56, s[52:55], s56 offen offset:0 lds
    buffer_load_dwordx4 v57, s[52:55], s56 offen offset:1024 lds
    buffer_load_dwordx4 v58, s[52:55], s56 offen offset:2048 lds
    buffer_load_dwordx4 v59, s[52:55], s56 offen offset:3072 lds
    s_waitcnt vmcnt(48)
    s_mov_b32 m0, 69632
    s_add_u32 s56, s56, 16384
    buffer_load_dwordx4 v56, s[52:55], s56 offen offset:0 lds
    buffer_load_dwordx4 v57, s[52:55], s56 offen offset:1024 lds
    buffer_load_dwordx4 v58, s[52:55], s56 offen offset:2048 lds
    buffer_load_dwordx4 v59, s[52:55], s56 offen offset:3072 lds
    s_waitcnt vmcnt(48)
    s_mov_b32 m0, 73728
    s_add_u32 s56, s56, 16384
    buffer_load_dwordx4 v56, s[52:55], s56 offen offset:0 lds
    buffer_load_dwordx4 v57, s[52:55], s56 offen offset:1024 lds
    buffer_load_dwordx4 v58, s[52:55], s56 offen offset:2048 lds
    buffer_load_dwordx4 v59, s[52:55], s56 offen offset:3072 lds
    s_waitcnt vmcnt(48)
    s_mov_b32 m0, 77824
    s_add_u32 s56, s56, 16384
    buffer_load_dwordx4 v56, s[52:55], s56 offen offset:0 lds
    buffer_load_dwordx4 v57, s[52:55], s56 offen offset:1024 lds
    buffer_load_dwordx4 v58, s[52:55], s56 offen offset:2048 lds
    buffer_load_dwordx4 v59, s[52:55], s56 offen offset:3072 lds
    s_waitcnt vmcnt(48)
L_concat_heads__ssm_conv_s4__grouped_kv_mqa__prompt_kernel_lw_1:
    ds_read_b32 v20, v10 offset:8
    s_waitcnt lgkmcnt(0)
    v_cmp_gt_u32 vcc, 1, v20
    s_cbranch_vccnz L_concat_heads__ssm_conv_s4__grouped_kv_mqa__prompt_kernel_lwr_2
    s_add_u32 s60, s59, 3
    s_and_b32 s60, s60, 3
    s_lshl_b32 s56, s60, 8
    s_add_u32 s56, s56, s57
    s_lshl_b32 s60, s60, 17
    s_add_u32 s60, s60, s61
    s_mov_b32 m0, 114688
    s_nop 0
    buffer_load_dwordx4 v222, s[12:15], s60 offen offset:0 lds
    buffer_load_dwordx4 v223, s[12:15], s60 offen offset:1024 lds
    buffer_load_dwordx4 v224, s[12:15], s60 offen offset:2048 lds
    buffer_load_dwordx4 v225, s[12:15], s60 offen offset:3072 lds
    s_waitcnt vmcnt(48)
    s_mov_b32 m0, 118784
    s_add_u32 s60, s60, 32768
    buffer_load_dwordx4 v222, s[12:15], s60 offen offset:0 lds
    buffer_load_dwordx4 v223, s[12:15], s60 offen offset:1024 lds
    buffer_load_dwordx4 v224, s[12:15], s60 offen offset:2048 lds
    buffer_load_dwordx4 v225, s[12:15], s60 offen offset:3072 lds
    s_waitcnt vmcnt(48)
    s_mov_b32 m0, 122880
    s_add_u32 s60, s60, 32768
    buffer_load_dwordx4 v222, s[12:15], s60 offen offset:0 lds
    buffer_load_dwordx4 v223, s[12:15], s60 offen offset:1024 lds
    buffer_load_dwordx4 v224, s[12:15], s60 offen offset:2048 lds
    buffer_load_dwordx4 v225, s[12:15], s60 offen offset:3072 lds
    s_waitcnt vmcnt(48)
    s_mov_b32 m0, 126976
    s_add_u32 s60, s60, 32768
    buffer_load_dwordx4 v222, s[12:15], s60 offen offset:0 lds
    buffer_load_dwordx4 v223, s[12:15], s60 offen offset:1024 lds
    buffer_load_dwordx4 v224, s[12:15], s60 offen offset:2048 lds
    buffer_load_dwordx4 v225, s[12:15], s60 offen offset:3072 lds
    s_waitcnt vmcnt(48)
    s_mov_b64 exec, 1
    ds_add_u32 v10, v9 offset:0
    s_mov_b64 exec, -1
    s_mov_b32 m0, 98304
    s_nop 0
    buffer_load_dwordx4 v56, s[52:55], s56 offen offset:0 lds
    buffer_load_dwordx4 v57, s[52:55], s56 offen offset:1024 lds
    buffer_load_dwordx4 v58, s[52:55], s56 offen offset:2048 lds
    buffer_load_dwordx4 v59, s[52:55], s56 offen offset:3072 lds
    s_waitcnt vmcnt(48)
    s_mov_b32 m0, 102400
    s_add_u32 s56, s56, 16384
    buffer_load_dwordx4 v56, s[52:55], s56 offen offset:0 lds
    buffer_load_dwordx4 v57, s[52:55], s56 offen offset:1024 lds
    buffer_load_dwordx4 v58, s[52:55], s56 offen offset:2048 lds
    buffer_load_dwordx4 v59, s[52:55], s56 offen offset:3072 lds
    s_waitcnt vmcnt(48)
    s_mov_b32 m0, 106496
    s_add_u32 s56, s56, 16384
    buffer_load_dwordx4 v56, s[52:55], s56 offen offset:0 lds
    buffer_load_dwordx4 v57, s[52:55], s56 offen offset:1024 lds
    buffer_load_dwordx4 v58, s[52:55], s56 offen offset:2048 lds
    buffer_load_dwordx4 v59, s[52:55], s56 offen offset:3072 lds
    s_waitcnt vmcnt(48)
    s_mov_b32 m0, 110592
    s_add_u32 s56, s56, 16384
    buffer_load_dwordx4 v56, s[52:55], s56 offen offset:0 lds
    buffer_load_dwordx4 v57, s[52:55], s56 offen offset:1024 lds
    buffer_load_dwordx4 v58, s[52:55], s56 offen offset:2048 lds
    buffer_load_dwordx4 v59, s[52:55], s56 offen offset:3072 lds
    s_waitcnt vmcnt(48)
    s_waitcnt vmcnt(32)
    s_mov_b64 exec, 1
    ds_add_u32 v10, v9 offset:0
    s_mov_b64 exec, -1
    s_waitcnt vmcnt(0)
    s_mov_b64 exec, 1
    ds_add_u32 v10, v9 offset:0
    s_mov_b64 exec, -1
    s_branch L_ldone
L_kv2:
    v_lshlrev_b32 v28, 8, v4
    v_lshl_add_u32 v28, v3, 3, v28
    v_add_u32 v28, 114688, v28
    v_xor_b32 v12, v4, v3
    v_lshlrev_b32 v12, 4, v12
    v_lshl_add_u32 v12, v3, 8, v12
    v_add_u32 v12, 98304, v12
    v_xor_b32 v13, 64, v12
    v_xor_b32 v14, 128, v12
    v_xor_b32 v15, 192, v12
    s_lshr_b32 s12, s60, 1
    s_lshl_b32 s12, s12, 10
    s_and_b32 s13, s60, 1
    s_lshl_b32 s13, s13, 8
    s_add_u32 s12, s12, s13
    s_add_u32 s13, s12, 65536
    s_cmp_eq_u32 s61, 0
    s_cselect_b32 s12, s12, s13
    s_cselect_b32 s13, 512, 8
    s_cselect_b32 s56, 8, 512
    s_cselect_b32 s57, 1052289595, 1.0
    v_and_b32 v29, 1, v4
    v_mul_lo_u32 v29, v29, s13
    v_lshrrev_b32 v30, 1, v4
    v_mul_lo_u32 v30, v30, s56
    v_lshl_add_u32 v29, v3, 4, v29
    v_add3_u32 v29, v29, v30, s12
    s_lshl1_add_u32 s12, s60, s61
    s_lshl_b32 s12, s12, 3
    s_add_u32 s12, s12, 163840
    v_mov_b32 v30, s12
    s_waitcnt lgkmcnt(0)
    s_mul_i32 s50, s50, 0x9e3779b1
    s_add_u32 s50, s50, 0x7f4a7c15
    s_xor_b32 s51, s51, s50
    s_mul_i32 s51, s51, 0x85ebca6b
    s_add_u32 s51, s51, 0x2545f491
    v_mov_b32 v244, s50
    v_mov_b32 v245, s51
    s_cmp_eq_u32 s61, 0
    s_cbranch_scc0 L_kvv
    s_waitcnt vmcnt(24)
    ds_read_b128 v[64:67], v12 offset:0
    ds_read_b64_tr_b16 v[128:129], v28 offset:0
    ds_read_b64_tr_b16 v[130:131], v28 offset:128
    ds_read_b128 v[68:71], v13 offset:0
    ds_read_b64_tr_b16 v[132:133], v28 offset:1024
    ds_read_b64_tr_b16 v[134:135], v28 offset:1152
    ds_read_b128 v[72:75], v14 offset:0
    ds_read_b64_tr_b16 v[136:137], v28 offset:2048
    ds_read_b64_tr_b16 v[138:139], v28 offset:2176
    ds_read_b128 v[76:79], v15 offset:0
    ds_read_b64_tr_b16 v[140:141], v28 offset:3072
    ds_read_b64_tr_b16 v[142:143], v28 offset:3200
    s_waitcnt vmcnt(16)
    ds_read_b128 v[80:83], v12 offset:4096
    ds_read_b64_tr_b16 v[144:145], v28 offset:4096
    ds_read_b64_tr_b16 v[146:147], v28 offset:4224
    ds_read_b128 v[84:87], v13 offset:4096
    ds_read_b64_tr_b16 v[148:149], v28 offset:5120
    ds_read_b64_tr_b16 v[150:151], v28 offset:5248
    ds_read_b128 v[88:91], v14 offset:4096
    ds_read_b64_tr_b16 v[152:153], v28 offset:6144
    ds_read_b64_tr_b16 v[154:155], v28 offset:6272
    ds_read_b128 v[92:95], v15 offset:4096
    ds_read_b64_tr_b16 v[156:157], v28 offset:7168
    ds_read_b64_tr_b16 v[158:159], v28 offset:7296
    s_waitcnt lgkmcnt(12)
    v_mfma_f32_16x16x32_bf16 v[32:35], v[128:131], v[64:67], 0
    v_mfma_f32_16x16x32_bf16 v[32:35], v[132:135], v[68:71], v[32:35]
    v_mfma_f32_16x16x32_bf16 v[32:35], v[136:139], v[72:75], v[32:35]
    v_mfma_f32_16x16x32_bf16 v[32:35], v[140:143], v[76:79], v[32:35]
    s_waitcnt vmcnt(8)
    ds_read_b128 v[96:99], v12 offset:8192
    ds_read_b64_tr_b16 v[160:161], v28 offset:8192
    ds_read_b64_tr_b16 v[162:163], v28 offset:8320
    ds_read_b128 v[100:103], v13 offset:8192
    ds_read_b64_tr_b16 v[164:165], v28 offset:9216
    ds_read_b64_tr_b16 v[166:167], v28 offset:9344
    ds_read_b128 v[104:107], v14 offset:8192
    ds_read_b64_tr_b16 v[168:169], v28 offset:10240
    ds_read_b64_tr_b16 v[170:171], v28 offset:10368
    ds_read_b128 v[108:111], v15 offset:8192
    ds_read_b64_tr_b16 v[172:173], v28 offset:11264
    ds_read_b64_tr_b16 v[174:175], v28 offset:11392
    s_waitcnt lgkmcnt(12)
    v_mfma_f32_16x16x32_bf16 v[32:35], v[144:147], v[80:83], v[32:35]
    v_mfma_f32_16x16x32_bf16 v[32:35], v[148:151], v[84:87], v[32:35]
    v_mfma_f32_16x16x32_bf16 v[32:35], v[152:155], v[88:91], v[32:35]
    v_mfma_f32_16x16x32_bf16 v[32:35], v[156:159], v[92:95], v[32:35]
    s_waitcnt vmcnt(0)
    ds_read_b128 v[112:115], v12 offset:12288
    ds_read_b64_tr_b16 v[176:177], v28 offset:12288
    ds_read_b64_tr_b16 v[178:179], v28 offset:12416
    ds_read_b128 v[116:119], v13 offset:12288
    ds_read_b64_tr_b16 v[180:181], v28 offset:13312
    ds_read_b64_tr_b16 v[182:183], v28 offset:13440
    ds_read_b128 v[120:123], v14 offset:12288
    ds_read_b64_tr_b16 v[184:185], v28 offset:14336
    ds_read_b64_tr_b16 v[186:187], v28 offset:14464
    ds_read_b128 v[124:127], v15 offset:12288
    ds_read_b64_tr_b16 v[188:189], v28 offset:15360
    ds_read_b64_tr_b16 v[190:191], v28 offset:15488
    s_waitcnt lgkmcnt(12)
    v_mfma_f32_16x16x32_bf16 v[32:35], v[160:163], v[96:99], v[32:35]
    v_mfma_f32_16x16x32_bf16 v[32:35], v[164:167], v[100:103], v[32:35]
    v_mfma_f32_16x16x32_bf16 v[32:35], v[168:171], v[104:107], v[32:35]
    v_mfma_f32_16x16x32_bf16 v[32:35], v[172:175], v[108:111], v[32:35]
    s_waitcnt lgkmcnt(0)
    v_mfma_f32_16x16x32_bf16 v[32:35], v[176:179], v[112:115], v[32:35]
    v_mfma_f32_16x16x32_bf16 v[32:35], v[180:183], v[116:119], v[32:35]
    v_mfma_f32_16x16x32_bf16 v[32:35], v[184:187], v[120:123], v[32:35]
    v_mfma_f32_16x16x32_bf16 v[32:35], v[188:191], v[124:127], v[32:35]
    s_mov_b64 exec, 1
    ds_add_u32 v10, v9 offset:8
    s_mov_b64 exec, -1
    s_nop 4
    v_mul_f32 v32, s57, v32
    v_mul_f32 v33, s57, v33
    v_mul_f32 v34, s57, v34
    v_mul_f32 v35, s57, v35
    v_cvt_pk_bf16_f32 v32, v32, v33
    v_cvt_pk_bf16_f32 v33, v34, v35
    global_store_dwordx2 v29, v[32:33], s[48:49] sc1
    s_branch L_kvd
L_kvv:
    s_waitcnt vmcnt(24)
    ds_read_b128 v[64:67], v12 offset:0
    ds_read_b64_tr_b16 v[128:129], v28 offset:0
    ds_read_b64_tr_b16 v[130:131], v28 offset:128
    ds_read_b128 v[68:71], v13 offset:0
    ds_read_b64_tr_b16 v[132:133], v28 offset:1024
    ds_read_b64_tr_b16 v[134:135], v28 offset:1152
    ds_read_b128 v[72:75], v14 offset:0
    ds_read_b64_tr_b16 v[136:137], v28 offset:2048
    ds_read_b64_tr_b16 v[138:139], v28 offset:2176
    ds_read_b128 v[76:79], v15 offset:0
    ds_read_b64_tr_b16 v[140:141], v28 offset:3072
    ds_read_b64_tr_b16 v[142:143], v28 offset:3200
    s_waitcnt vmcnt(16)
    ds_read_b128 v[80:83], v12 offset:4096
    ds_read_b64_tr_b16 v[144:145], v28 offset:4096
    ds_read_b64_tr_b16 v[146:147], v28 offset:4224
    ds_read_b128 v[84:87], v13 offset:4096
    ds_read_b64_tr_b16 v[148:149], v28 offset:5120
    ds_read_b64_tr_b16 v[150:151], v28 offset:5248
    ds_read_b128 v[88:91], v14 offset:4096
    ds_read_b64_tr_b16 v[152:153], v28 offset:6144
    ds_read_b64_tr_b16 v[154:155], v28 offset:6272
    ds_read_b128 v[92:95], v15 offset:4096
    ds_read_b64_tr_b16 v[156:157], v28 offset:7168
    ds_read_b64_tr_b16 v[158:159], v28 offset:7296
    s_waitcnt lgkmcnt(12)
    v_mfma_f32_16x16x32_bf16 v[32:35], v[64:67], v[128:131], 0
    v_mfma_f32_16x16x32_bf16 v[32:35], v[68:71], v[132:135], v[32:35]
    v_mfma_f32_16x16x32_bf16 v[32:35], v[72:75], v[136:139], v[32:35]
    v_mfma_f32_16x16x32_bf16 v[32:35], v[76:79], v[140:143], v[32:35]
    s_waitcnt vmcnt(8)
    ds_read_b128 v[96:99], v12 offset:8192
    ds_read_b64_tr_b16 v[160:161], v28 offset:8192
    ds_read_b64_tr_b16 v[162:163], v28 offset:8320
    ds_read_b128 v[100:103], v13 offset:8192
    ds_read_b64_tr_b16 v[164:165], v28 offset:9216
    ds_read_b64_tr_b16 v[166:167], v28 offset:9344
    ds_read_b128 v[104:107], v14 offset:8192
    ds_read_b64_tr_b16 v[168:169], v28 offset:10240
    ds_read_b64_tr_b16 v[170:171], v28 offset:10368
    ds_read_b128 v[108:111], v15 offset:8192
    ds_read_b64_tr_b16 v[172:173], v28 offset:11264
    ds_read_b64_tr_b16 v[174:175], v28 offset:11392
    s_waitcnt lgkmcnt(12)
    v_mfma_f32_16x16x32_bf16 v[32:35], v[80:83], v[144:147], v[32:35]
    v_mfma_f32_16x16x32_bf16 v[32:35], v[84:87], v[148:151], v[32:35]
    v_mfma_f32_16x16x32_bf16 v[32:35], v[88:91], v[152:155], v[32:35]
    v_mfma_f32_16x16x32_bf16 v[32:35], v[92:95], v[156:159], v[32:35]
    s_waitcnt vmcnt(0)
    ds_read_b128 v[112:115], v12 offset:12288
    ds_read_b64_tr_b16 v[176:177], v28 offset:12288
    ds_read_b64_tr_b16 v[178:179], v28 offset:12416
    ds_read_b128 v[116:119], v13 offset:12288
    ds_read_b64_tr_b16 v[180:181], v28 offset:13312
    ds_read_b64_tr_b16 v[182:183], v28 offset:13440
    ds_read_b128 v[120:123], v14 offset:12288
    ds_read_b64_tr_b16 v[184:185], v28 offset:14336
    ds_read_b64_tr_b16 v[186:187], v28 offset:14464
    ds_read_b128 v[124:127], v15 offset:12288
    ds_read_b64_tr_b16 v[188:189], v28 offset:15360
    ds_read_b64_tr_b16 v[190:191], v28 offset:15488
    s_waitcnt lgkmcnt(12)
    v_mfma_f32_16x16x32_bf16 v[32:35], v[96:99], v[160:163], v[32:35]
    v_mfma_f32_16x16x32_bf16 v[32:35], v[100:103], v[164:167], v[32:35]
    v_mfma_f32_16x16x32_bf16 v[32:35], v[104:107], v[168:171], v[32:35]
    v_mfma_f32_16x16x32_bf16 v[32:35], v[108:111], v[172:175], v[32:35]
    s_waitcnt lgkmcnt(0)
    v_mfma_f32_16x16x32_bf16 v[32:35], v[112:115], v[176:179], v[32:35]
    v_mfma_f32_16x16x32_bf16 v[32:35], v[116:119], v[180:183], v[32:35]
    v_mfma_f32_16x16x32_bf16 v[32:35], v[120:123], v[184:187], v[32:35]
    v_mfma_f32_16x16x32_bf16 v[32:35], v[124:127], v[188:191], v[32:35]
    s_mov_b64 exec, 1
    ds_add_u32 v10, v9 offset:8
    s_mov_b64 exec, -1
    s_nop 4
    v_cvt_pk_bf16_f32 v32, v32, v33
    v_cvt_pk_bf16_f32 v33, v34, v35
    global_store_dwordx2 v29, v[32:33], s[48:49] sc1
L_kvd:
    s_waitcnt vmcnt(0)
    s_mov_b64 exec, 1
    global_store_dwordx2 v30, v[244:245], s[48:49] sc1
    s_mov_b64 exec, -1
    s_setprio 1
    s_call_b64 s[64:65], L_setup
    s_branch L_t1
L_kgen:
    s_call_b64 s[64:65], L_setup
    s_waitcnt lgkmcnt(0)
    s_lshl_b32 s12, s14, 4
    s_lshr_b32 s12, s60, s12
    s_lshl_b32 s12, s12, 16
    v_mov_b32 v198, s12
    v_mul_f32 v198, 1069066811, v198
    v_exp_f32 v198, v198
    s_nop 0
    v_cvt_pk_bf16_f32 v198, v198, v198
    v_and_b32 v198, 0xffff0000, v198
    s_mul_i32 s50, s50, 0x9e3779b1
    s_add_u32 s50, s50, 0x7f4a7c15
    s_xor_b32 s51, s51, s50
    s_mul_i32 s51, s51, 0x85ebca6b
    s_add_u32 s51, s51, 0x2545f491
    v_mov_b32 v244, s50
    v_mov_b32 v245, s51
    s_waitcnt vmcnt(0)
    v_lshlrev_b32 v16, 16, v192
    v_lshlrev_b32 v17, 16, v193
    v_lshlrev_b32 v18, 16, v194
    v_lshlrev_b32 v19, 16, v195
    v_lshlrev_b32 v20, 16, v196
    v_lshlrev_b32 v21, 16, v197
    v_mul_f32 v16, v16, v198
    v_mul_f32 v17, v17, v198
    v_mul_f32 v16, 1069066811, v16
    v_mul_f32 v17, 0.15915494, v17
    v_mul_f32 v22, 0x41000000, v16
    v_mul_f32 v23, 0x41000000, v17
    v_mul_f32 v24, 0x43800000, v16
    v_mul_f32 v25, 0x43800000, v17
    v_exp_f32 v16, v16
    v_exp_f32 v22, v22
    v_exp_f32 v24, v24
    v_fract_f32 v17, v17
    v_fract_f32 v23, v23
    v_fract_f32 v25, v25
    v_cos_f32 v32, v17
    v_sin_f32 v33, v17
    v_cos_f32 v38, v23
    v_sin_f32 v39, v23
    v_cos_f32 v40, v25
    v_sin_f32 v41, v25
    v_pk_mul_f32 v[60:61], v[20:21], v[18:19] op_sel:[0,0] op_sel_hi:[1,0]
    v_pk_fma_f32 v[42:43], v[20:21], v[18:19], v[60:61] op_sel:[1,1,0] op_sel_hi:[0,1,1] neg_lo:[1,0,0]
    v_pk_mul_f32 v[32:33], v[32:33], v[16:17] op_sel_hi:[1,0]
    v_pk_mul_f32 v[38:39], v[38:39], v[22:23] op_sel_hi:[1,0]
    v_pk_mul_f32 v[40:41], v[40:41], v[24:25] op_sel_hi:[1,0]
    v_pk_mul_f32 v[42:43], v[42:43], v[198:199] op_sel_hi:[1,0]
    v_pk_mul_f32 v[52:53], v[38:39], v[38:39] op_sel:[0,0] op_sel_hi:[1,0]
    v_pk_fma_f32 v[26:27], v[38:39], v[38:39], v[52:53] op_sel:[1,1,0] op_sel_hi:[0,1,1] neg_lo:[1,0,0]
    v_cvt_pk_bf16_f32 v64, v42, -v43
    v_pk_mul_f32 v[48:49], v[32:33], v[32:33] op_sel:[0,0] op_sel_hi:[1,0]
    v_mov_b32 v96, 0x3f80
    v_cvt_pk_bf16_f32 v97, v38, v39
    v_pk_mul_f32 v[46:47], v[42:43], v[32:33] op_sel:[0,0] op_sel_hi:[1,0]
    v_pk_fma_f32 v[34:35], v[32:33], v[32:33], v[48:49] op_sel:[1,1,0] op_sel_hi:[0,1,1] neg_lo:[1,0,0]
    v_cvt_pk_bf16_f32 v98, v26, v27
    v_pk_mul_f32 v[54:55], v[38:39], v[26:27] op_sel:[0,0] op_sel_hi:[1,0]
    v_pk_fma_f32 v[44:45], v[42:43], v[32:33], v[46:47] op_sel:[1,1,0] op_sel_hi:[0,1,1] neg_lo:[1,0,0]
    v_pk_mul_f32 v[50:51], v[42:43], v[40:41] op_sel:[0,0] op_sel_hi:[1,0]
    v_pk_mul_f32 v[52:53], v[26:27], v[26:27] op_sel:[0,0] op_sel_hi:[1,0]
    v_pk_fma_f32 v[30:31], v[38:39], v[26:27], v[54:55] op_sel:[1,1,0] op_sel_hi:[0,1,1] neg_lo:[1,0,0]
    v_cvt_pk_bf16_f32 v65, v44, -v45
    v_pk_fma_f32 v[12:13], v[42:43], v[40:41], v[50:51] op_sel:[1,1,0] op_sel_hi:[0,1,1] neg_lo:[1,0,0]
    v_pk_fma_f32 v[28:29], v[26:27], v[26:27], v[52:53] op_sel:[1,1,0] op_sel_hi:[0,1,1] neg_lo:[1,0,0]
    v_cvt_pk_bf16_f32 v99, v30, v31
    v_pk_mul_f32 v[46:47], v[44:45], v[32:33] op_sel:[0,0] op_sel_hi:[1,0]
    v_pk_mul_f32 v[48:49], v[34:35], v[34:35] op_sel:[0,0] op_sel_hi:[1,0]
    v_cvt_pk_bf16_f32 v100, v28, v29
    v_pk_mul_f32 v[54:55], v[30:31], v[26:27] op_sel:[0,0] op_sel_hi:[1,0]
    v_pk_fma_f32 v[44:45], v[44:45], v[32:33], v[46:47] op_sel:[1,1,0] op_sel_hi:[0,1,1] neg_lo:[1,0,0]
    v_pk_fma_f32 v[36:37], v[34:35], v[34:35], v[48:49] op_sel:[1,1,0] op_sel_hi:[0,1,1] neg_lo:[1,0,0]
    v_pk_mul_f32 v[52:53], v[28:29], v[26:27] op_sel:[0,0] op_sel_hi:[1,0]
    v_pk_fma_f32 v[30:31], v[30:31], v[26:27], v[54:55] op_sel:[1,1,0] op_sel_hi:[0,1,1] neg_lo:[1,0,0]
    v_cvt_pk_bf16_f32 v66, v44, -v45
    v_cvt_pk_bf16_f32 v73, v12, -v13
    v_pk_fma_f32 v[28:29], v[28:29], v[26:27], v[52:53] op_sel:[1,1,0] op_sel_hi:[0,1,1] neg_lo:[1,0,0]
    v_cvt_pk_bf16_f32 v101, v30, v31
    v_pk_mul_f32 v[46:47], v[44:45], v[32:33] op_sel:[0,0] op_sel_hi:[1,0]
    v_pk_mul_f32 v[50:51], v[12:13], v[40:41] op_sel:[0,0] op_sel_hi:[1,0]
    v_cvt_pk_bf16_f32 v102, v28, v29
    v_pk_mul_f32 v[54:55], v[30:31], v[26:27] op_sel:[0,0] op_sel_hi:[1,0]
    v_pk_fma_f32 v[44:45], v[44:45], v[32:33], v[46:47] op_sel:[1,1,0] op_sel_hi:[0,1,1] neg_lo:[1,0,0]
    v_pk_fma_f32 v[56:57], v[12:13], v[40:41], v[50:51] op_sel:[1,1,0] op_sel_hi:[0,1,1] neg_lo:[1,0,0]
    v_pk_mul_f32 v[52:53], v[28:29], v[26:27] op_sel:[0,0] op_sel_hi:[1,0]
    v_pk_fma_f32 v[30:31], v[30:31], v[26:27], v[54:55] op_sel:[1,1,0] op_sel_hi:[0,1,1] neg_lo:[1,0,0]
    v_cvt_pk_bf16_f32 v67, v44, -v45
    v_cvt_pk_bf16_f32 v80, v56, -v57
    v_pk_fma_f32 v[28:29], v[28:29], v[26:27], v[52:53] op_sel:[1,1,0] op_sel_hi:[0,1,1] neg_lo:[1,0,0]
    v_cvt_pk_bf16_f32 v103, v30, v31
    v_pk_mul_f32 v[46:47], v[44:45], v[32:33] op_sel:[0,0] op_sel_hi:[1,0]
    v_pk_mul_f32 v[48:49], v[56:57], v[36:37] op_sel:[0,0] op_sel_hi:[1,0]
    v_cvt_pk_bf16_f32 v104, v28, v29
    v_pk_mul_f32 v[54:55], v[30:31], v[26:27] op_sel:[0,0] op_sel_hi:[1,0]
    v_pk_fma_f32 v[44:45], v[44:45], v[32:33], v[46:47] op_sel:[1,1,0] op_sel_hi:[0,1,1] neg_lo:[1,0,0]
    v_pk_fma_f32 v[14:15], v[56:57], v[36:37], v[48:49] op_sel:[1,1,0] op_sel_hi:[0,1,1] neg_lo:[1,0,0]
    v_pk_mul_f32 v[52:53], v[28:29], v[26:27] op_sel:[0,0] op_sel_hi:[1,0]
    v_pk_fma_f32 v[30:31], v[30:31], v[26:27], v[54:55] op_sel:[1,1,0] op_sel_hi:[0,1,1] neg_lo:[1,0,0]
    v_cvt_pk_bf16_f32 v72, v44, -v45
    v_cvt_pk_bf16_f32 v81, v14, -v15
    v_pk_fma_f32 v[28:29], v[28:29], v[26:27], v[52:53] op_sel:[1,1,0] op_sel_hi:[0,1,1] neg_lo:[1,0,0]
    v_cvt_pk_bf16_f32 v105, v30, v31
    v_pk_mul_f32 v[46:47], v[44:45], v[32:33] op_sel:[0,0] op_sel_hi:[1,0]
    v_pk_mul_f32 v[48:49], v[14:15], v[36:37] op_sel:[0,0] op_sel_hi:[1,0]
    v_cvt_pk_bf16_f32 v106, v28, v29
    v_pk_mul_f32 v[54:55], v[30:31], v[26:27] op_sel:[0,0] op_sel_hi:[1,0]
    v_pk_fma_f32 v[44:45], v[44:45], v[32:33], v[46:47] op_sel:[1,1,0] op_sel_hi:[0,1,1] neg_lo:[1,0,0]
    v_pk_fma_f32 v[14:15], v[14:15], v[36:37], v[48:49] op_sel:[1,1,0] op_sel_hi:[0,1,1] neg_lo:[1,0,0]
    v_pk_mul_f32 v[52:53], v[28:29], v[26:27] op_sel:[0,0] op_sel_hi:[1,0]
    v_pk_fma_f32 v[30:31], v[30:31], v[26:27], v[54:55] op_sel:[1,1,0] op_sel_hi:[0,1,1] neg_lo:[1,0,0]
    v_cvt_pk_bf16_f32 v69, v44, -v45
    v_cvt_pk_bf16_f32 v82, v14, -v15
    v_pk_fma_f32 v[28:29], v[28:29], v[26:27], v[52:53] op_sel:[1,1,0] op_sel_hi:[0,1,1] neg_lo:[1,0,0]
    v_cvt_pk_bf16_f32 v107, v30, v31
    v_pk_mul_f32 v[46:47], v[44:45], v[32:33] op_sel:[0,0] op_sel_hi:[1,0]
    v_pk_mul_f32 v[50:51], v[56:57], v[40:41] op_sel:[0,0] op_sel_hi:[1,0]
    v_cvt_pk_bf16_f32 v108, v28, v29
    v_pk_mul_f32 v[54:55], v[30:31], v[26:27] op_sel:[0,0] op_sel_hi:[1,0]
    v_pk_fma_f32 v[44:45], v[44:45], v[32:33], v[46:47] op_sel:[1,1,0] op_sel_hi:[0,1,1] neg_lo:[1,0,0]
    v_pk_fma_f32 v[58:59], v[56:57], v[40:41], v[50:51] op_sel:[1,1,0] op_sel_hi:[0,1,1] neg_lo:[1,0,0]
    v_pk_mul_f32 v[52:53], v[28:29], v[26:27] op_sel:[0,0] op_sel_hi:[1,0]
    v_pk_fma_f32 v[30:31], v[30:31], v[26:27], v[54:55] op_sel:[1,1,0] op_sel_hi:[0,1,1] neg_lo:[1,0,0]
    v_cvt_pk_bf16_f32 v70, v44, -v45
    v_cvt_pk_bf16_f32 v84, v58, -v59
    v_pk_fma_f32 v[28:29], v[28:29], v[26:27], v[52:53] op_sel:[1,1,0] op_sel_hi:[0,1,1] neg_lo:[1,0,0]
    v_cvt_pk_bf16_f32 v109, v30, v31
    v_pk_mul_f32 v[46:47], v[44:45], v[32:33] op_sel:[0,0] op_sel_hi:[1,0]
    v_pk_mul_f32 v[48:49], v[58:59], v[36:37] op_sel:[0,0] op_sel_hi:[1,0]
    v_cvt_pk_bf16_f32 v110, v28, v29
    v_pk_mul_f32 v[54:55], v[30:31], v[26:27] op_sel:[0,0] op_sel_hi:[1,0]
    v_pk_fma_f32 v[44:45], v[44:45], v[32:33], v[46:47] op_sel:[1,1,0] op_sel_hi:[0,1,1] neg_lo:[1,0,0]
    v_pk_fma_f32 v[14:15], v[58:59], v[36:37], v[48:49] op_sel:[1,1,0] op_sel_hi:[0,1,1] neg_lo:[1,0,0]
    v_pk_mul_f32 v[52:53], v[28:29], v[26:27] op_sel:[0,0] op_sel_hi:[1,0]
    v_pk_fma_f32 v[30:31], v[30:31], v[26:27], v[54:55] op_sel:[1,1,0] op_sel_hi:[0,1,1] neg_lo:[1,0,0]
    v_cvt_pk_bf16_f32 v71, v44, -v45
    v_cvt_pk_bf16_f32 v85, v14, -v15
    v_pk_fma_f32 v[28:29], v[28:29], v[26:27], v[52:53] op_sel:[1,1,0] op_sel_hi:[0,1,1] neg_lo:[1,0,0]
    v_cvt_pk_bf16_f32 v111, v30, v31
    v_pk_mul_f32 v[46:47], v[44:45], v[32:33] op_sel:[0,0] op_sel_hi:[1,0]
    v_pk_mul_f32 v[48:49], v[14:15], v[36:37] op_sel:[0,0] op_sel_hi:[1,0]
    v_cvt_pk_bf16_f32 v112, v28, v29
    v_pk_mul_f32 v[54:55], v[30:31], v[26:27] op_sel:[0,0] op_sel_hi:[1,0]
    v_pk_fma_f32 v[44:45], v[44:45], v[32:33], v[46:47] op_sel:[1,1,0] op_sel_hi:[0,1,1] neg_lo:[1,0,0]
    v_pk_fma_f32 v[14:15], v[14:15], v[36:37], v[48:49] op_sel:[1,1,0] op_sel_hi:[0,1,1] neg_lo:[1,0,0]
    v_pk_mul_f32 v[52:53], v[28:29], v[26:27] op_sel:[0,0] op_sel_hi:[1,0]
    v_pk_fma_f32 v[30:31], v[30:31], v[26:27], v[54:55] op_sel:[1,1,0] op_sel_hi:[0,1,1] neg_lo:[1,0,0]
    v_cvt_pk_bf16_f32 v76, v44, -v45
    v_cvt_pk_bf16_f32 v86, v14, -v15
    v_pk_fma_f32 v[28:29], v[28:29], v[26:27], v[52:53] op_sel:[1,1,0] op_sel_hi:[0,1,1] neg_lo:[1,0,0]
    v_cvt_pk_bf16_f32 v113, v30, v31
    v_pk_mul_f32 v[46:47], v[12:13], v[34:35] op_sel:[0,0] op_sel_hi:[1,0]
    v_pk_mul_f32 v[50:51], v[58:59], v[40:41] op_sel:[0,0] op_sel_hi:[1,0]
    v_cvt_pk_bf16_f32 v114, v28, v29
    v_pk_mul_f32 v[54:55], v[30:31], v[26:27] op_sel:[0,0] op_sel_hi:[1,0]
    v_pk_fma_f32 v[44:45], v[12:13], v[34:35], v[46:47] op_sel:[1,1,0] op_sel_hi:[0,1,1] neg_lo:[1,0,0]
    v_pk_fma_f32 v[56:57], v[58:59], v[40:41], v[50:51] op_sel:[1,1,0] op_sel_hi:[0,1,1] neg_lo:[1,0,0]
    v_pk_mul_f32 v[52:53], v[28:29], v[26:27] op_sel:[0,0] op_sel_hi:[1,0]
    v_pk_fma_f32 v[30:31], v[30:31], v[26:27], v[54:55] op_sel:[1,1,0] op_sel_hi:[0,1,1] neg_lo:[1,0,0]
    v_cvt_pk_bf16_f32 v74, v44, -v45
    v_cvt_pk_bf16_f32 v83, v56, -v57
    v_pk_fma_f32 v[28:29], v[28:29], v[26:27], v[52:53] op_sel:[1,1,0] op_sel_hi:[0,1,1] neg_lo:[1,0,0]
    v_cvt_pk_bf16_f32 v115, v30, v31
    v_pk_mul_f32 v[46:47], v[44:45], v[34:35] op_sel:[0,0] op_sel_hi:[1,0]
    v_pk_mul_f32 v[48:49], v[56:57], v[38:39] op_sel:[0,0] op_sel_hi:[1,0]
    v_cvt_pk_bf16_f32 v116, v28, v29
    v_pk_mul_f32 v[54:55], v[30:31], v[26:27] op_sel:[0,0] op_sel_hi:[1,0]
    v_pk_fma_f32 v[44:45], v[44:45], v[34:35], v[46:47] op_sel:[1,1,0] op_sel_hi:[0,1,1] neg_lo:[1,0,0]
    v_pk_fma_f32 v[14:15], v[56:57], v[38:39], v[48:49] op_sel:[1,1,0] op_sel_hi:[0,1,1] neg_lo:[1,0,0]
    v_pk_mul_f32 v[52:53], v[28:29], v[26:27] op_sel:[0,0] op_sel_hi:[1,0]
    v_pk_fma_f32 v[30:31], v[30:31], v[26:27], v[54:55] op_sel:[1,1,0] op_sel_hi:[0,1,1] neg_lo:[1,0,0]
    v_cvt_pk_bf16_f32 v75, v44, -v45
    v_cvt_pk_bf16_f32 v88, v14, -v15
    v_pk_fma_f32 v[28:29], v[28:29], v[26:27], v[52:53] op_sel:[1,1,0] op_sel_hi:[0,1,1] neg_lo:[1,0,0]
    v_cvt_pk_bf16_f32 v117, v30, v31
    v_pk_mul_f32 v[46:47], v[44:45], v[34:35] op_sel:[0,0] op_sel_hi:[1,0]
    v_pk_mul_f32 v[50:51], v[56:57], v[40:41] op_sel:[0,0] op_sel_hi:[1,0]
    v_cvt_pk_bf16_f32 v118, v28, v29
    v_pk_mul_f32 v[54:55], v[30:31], v[26:27] op_sel:[0,0] op_sel_hi:[1,0]
    v_pk_fma_f32 v[44:45], v[44:45], v[34:35], v[46:47] op_sel:[1,1,0] op_sel_hi:[0,1,1] neg_lo:[1,0,0]
    v_pk_fma_f32 v[58:59], v[56:57], v[40:41], v[50:51] op_sel:[1,1,0] op_sel_hi:[0,1,1] neg_lo:[1,0,0]
    v_pk_mul_f32 v[52:53], v[28:29], v[26:27] op_sel:[0,0] op_sel_hi:[1,0]
    v_pk_fma_f32 v[30:31], v[30:31], v[26:27], v[54:55] op_sel:[1,1,0] op_sel_hi:[0,1,1] neg_lo:[1,0,0]
    v_cvt_pk_bf16_f32 v78, v44, -v45
    v_cvt_pk_bf16_f32 v87, v58, -v59
    v_pk_fma_f32 v[28:29], v[28:29], v[26:27], v[52:53] op_sel:[1,1,0] op_sel_hi:[0,1,1] neg_lo:[1,0,0]
    v_cvt_pk_bf16_f32 v119, v30, v31
    v_pk_mul_f32 v[46:47], v[44:45], v[34:35] op_sel:[0,0] op_sel_hi:[1,0]
    v_pk_mul_f32 v[48:49], v[58:59], v[38:39] op_sel:[0,0] op_sel_hi:[1,0]
    v_cvt_pk_bf16_f32 v120, v28, v29
    v_pk_mul_f32 v[54:55], v[30:31], v[26:27] op_sel:[0,0] op_sel_hi:[1,0]
    v_pk_fma_f32 v[44:45], v[44:45], v[34:35], v[46:47] op_sel:[1,1,0] op_sel_hi:[0,1,1] neg_lo:[1,0,0]
    v_pk_fma_f32 v[14:15], v[58:59], v[38:39], v[48:49] op_sel:[1,1,0] op_sel_hi:[0,1,1] neg_lo:[1,0,0]
    v_pk_mul_f32 v[52:53], v[28:29], v[26:27] op_sel:[0,0] op_sel_hi:[1,0]
    v_pk_fma_f32 v[30:31], v[30:31], v[26:27], v[54:55] op_sel:[1,1,0] op_sel_hi:[0,1,1] neg_lo:[1,0,0]
    v_cvt_pk_bf16_f32 v79, v44, -v45
    v_cvt_pk_bf16_f32 v92, v14, -v15
    v_pk_fma_f32 v[28:29], v[28:29], v[26:27], v[52:53] op_sel:[1,1,0] op_sel_hi:[0,1,1] neg_lo:[1,0,0]
    v_cvt_pk_bf16_f32 v121, v30, v31
    v_pk_mul_f32 v[50:51], v[58:59], v[40:41] op_sel:[0,0] op_sel_hi:[1,0]
    v_cvt_pk_bf16_f32 v122, v28, v29
    v_pk_mul_f32 v[54:55], v[30:31], v[26:27] op_sel:[0,0] op_sel_hi:[1,0]
    v_pk_fma_f32 v[56:57], v[58:59], v[40:41], v[50:51] op_sel:[1,1,0] op_sel_hi:[0,1,1] neg_lo:[1,0,0]
    v_pk_mul_f32 v[52:53], v[28:29], v[26:27] op_sel:[0,0] op_sel_hi:[1,0]
    v_pk_fma_f32 v[30:31], v[30:31], v[26:27], v[54:55] op_sel:[1,1,0] op_sel_hi:[0,1,1] neg_lo:[1,0,0]
    v_cvt_pk_bf16_f32 v89, v56, -v57
    v_pk_fma_f32 v[28:29], v[28:29], v[26:27], v[52:53] op_sel:[1,1,0] op_sel_hi:[0,1,1] neg_lo:[1,0,0]
    v_cvt_pk_bf16_f32 v123, v30, v31
    v_pk_mul_f32 v[48:49], v[56:57], v[38:39] op_sel:[0,0] op_sel_hi:[1,0]
    v_cvt_pk_bf16_f32 v124, v28, v29
    v_pk_mul_f32 v[54:55], v[30:31], v[26:27] op_sel:[0,0] op_sel_hi:[1,0]
    v_pk_fma_f32 v[14:15], v[56:57], v[38:39], v[48:49] op_sel:[1,1,0] op_sel_hi:[0,1,1] neg_lo:[1,0,0]
    v_pk_mul_f32 v[52:53], v[28:29], v[26:27] op_sel:[0,0] op_sel_hi:[1,0]
    v_pk_fma_f32 v[30:31], v[30:31], v[26:27], v[54:55] op_sel:[1,1,0] op_sel_hi:[0,1,1] neg_lo:[1,0,0]
    v_cvt_pk_bf16_f32 v90, v14, -v15
    v_pk_fma_f32 v[28:29], v[28:29], v[26:27], v[52:53] op_sel:[1,1,0] op_sel_hi:[0,1,1] neg_lo:[1,0,0]
    v_cvt_pk_bf16_f32 v125, v30, v31
    v_pk_mul_f32 v[50:51], v[56:57], v[40:41] op_sel:[0,0] op_sel_hi:[1,0]
    v_cvt_pk_bf16_f32 v126, v28, v29
    v_pk_mul_f32 v[54:55], v[30:31], v[26:27] op_sel:[0,0] op_sel_hi:[1,0]
    v_pk_fma_f32 v[58:59], v[56:57], v[40:41], v[50:51] op_sel:[1,1,0] op_sel_hi:[0,1,1] neg_lo:[1,0,0]
    v_pk_fma_f32 v[30:31], v[30:31], v[26:27], v[54:55] op_sel:[1,1,0] op_sel_hi:[0,1,1] neg_lo:[1,0,0]
    v_cvt_pk_bf16_f32 v93, v58, -v59
    v_cvt_pk_bf16_f32 v127, v30, v31
    v_pk_mul_f32 v[48:49], v[58:59], v[38:39] op_sel:[0,0] op_sel_hi:[1,0]
    v_pk_fma_f32 v[14:15], v[58:59], v[38:39], v[48:49] op_sel:[1,1,0] op_sel_hi:[0,1,1] neg_lo:[1,0,0]
    v_cvt_pk_bf16_f32 v94, v14, -v15
    v_and_b32 v16, 0xffff0000, v192
    v_and_b32 v17, 0xffff0000, v193
    v_and_b32 v18, 0xffff0000, v194
    v_and_b32 v19, 0xffff0000, v195
    v_and_b32 v20, 0xffff0000, v196
    v_and_b32 v21, 0xffff0000, v197
    v_mul_f32 v16, v16, v198
    v_mul_f32 v17, v17, v198
    v_mul_f32 v16, 1069066811, v16
    v_mul_f32 v17, 0.15915494, v17
    v_mul_f32 v22, 0x41000000, v16
    v_mul_f32 v23, 0x41000000, v17
    v_mul_f32 v24, 0x43800000, v16
    v_mul_f32 v25, 0x43800000, v17
    v_exp_f32 v16, v16
    v_exp_f32 v22, v22
    v_exp_f32 v24, v24
    v_fract_f32 v17, v17
    v_fract_f32 v23, v23
    v_fract_f32 v25, v25
    v_cos_f32 v32, v17
    v_sin_f32 v33, v17
    v_cos_f32 v38, v23
    v_sin_f32 v39, v23
    v_cos_f32 v40, v25
    v_sin_f32 v41, v25
    v_pk_mul_f32 v[60:61], v[20:21], v[18:19] op_sel:[0,0] op_sel_hi:[1,0]
    v_pk_fma_f32 v[42:43], v[20:21], v[18:19], v[60:61] op_sel:[1,1,0] op_sel_hi:[0,1,1] neg_lo:[1,0,0]
    v_pk_mul_f32 v[32:33], v[32:33], v[16:17] op_sel_hi:[1,0]
    v_pk_mul_f32 v[38:39], v[38:39], v[22:23] op_sel_hi:[1,0]
    v_pk_mul_f32 v[40:41], v[40:41], v[24:25] op_sel_hi:[1,0]
    v_pk_mul_f32 v[42:43], v[42:43], v[198:199] op_sel_hi:[1,0]
    v_pk_mul_f32 v[52:53], v[38:39], v[38:39] op_sel:[0,0] op_sel_hi:[1,0]
    v_pk_fma_f32 v[26:27], v[38:39], v[38:39], v[52:53] op_sel:[1,1,0] op_sel_hi:[0,1,1] neg_lo:[1,0,0]
    v_cvt_pk_bf16_f32 v128, v42, -v43
    v_pk_mul_f32 v[48:49], v[32:33], v[32:33] op_sel:[0,0] op_sel_hi:[1,0]
    v_mov_b32 v160, 0x3f80
    v_cvt_pk_bf16_f32 v161, v38, v39
    v_pk_mul_f32 v[46:47], v[42:43], v[32:33] op_sel:[0,0] op_sel_hi:[1,0]
    v_pk_fma_f32 v[34:35], v[32:33], v[32:33], v[48:49] op_sel:[1,1,0] op_sel_hi:[0,1,1] neg_lo:[1,0,0]
    v_cvt_pk_bf16_f32 v162, v26, v27
    v_pk_mul_f32 v[54:55], v[38:39], v[26:27] op_sel:[0,0] op_sel_hi:[1,0]
    v_pk_fma_f32 v[44:45], v[42:43], v[32:33], v[46:47] op_sel:[1,1,0] op_sel_hi:[0,1,1] neg_lo:[1,0,0]
    v_pk_mul_f32 v[50:51], v[42:43], v[40:41] op_sel:[0,0] op_sel_hi:[1,0]
    v_pk_mul_f32 v[52:53], v[26:27], v[26:27] op_sel:[0,0] op_sel_hi:[1,0]
    v_pk_fma_f32 v[30:31], v[38:39], v[26:27], v[54:55] op_sel:[1,1,0] op_sel_hi:[0,1,1] neg_lo:[1,0,0]
    v_cvt_pk_bf16_f32 v129, v44, -v45
    v_pk_fma_f32 v[12:13], v[42:43], v[40:41], v[50:51] op_sel:[1,1,0] op_sel_hi:[0,1,1] neg_lo:[1,0,0]
    v_pk_fma_f32 v[28:29], v[26:27], v[26:27], v[52:53] op_sel:[1,1,0] op_sel_hi:[0,1,1] neg_lo:[1,0,0]
    v_cvt_pk_bf16_f32 v163, v30, v31
    v_pk_mul_f32 v[46:47], v[44:45], v[32:33] op_sel:[0,0] op_sel_hi:[1,0]
    v_pk_mul_f32 v[48:49], v[34:35], v[34:35] op_sel:[0,0] op_sel_hi:[1,0]
    v_cvt_pk_bf16_f32 v164, v28, v29
    v_pk_mul_f32 v[54:55], v[30:31], v[26:27] op_sel:[0,0] op_sel_hi:[1,0]
    v_pk_fma_f32 v[44:45], v[44:45], v[32:33], v[46:47] op_sel:[1,1,0] op_sel_hi:[0,1,1] neg_lo:[1,0,0]
    v_pk_fma_f32 v[36:37], v[34:35], v[34:35], v[48:49] op_sel:[1,1,0] op_sel_hi:[0,1,1] neg_lo:[1,0,0]
    v_pk_mul_f32 v[52:53], v[28:29], v[26:27] op_sel:[0,0] op_sel_hi:[1,0]
    v_pk_fma_f32 v[30:31], v[30:31], v[26:27], v[54:55] op_sel:[1,1,0] op_sel_hi:[0,1,1] neg_lo:[1,0,0]
    v_cvt_pk_bf16_f32 v130, v44, -v45
    v_cvt_pk_bf16_f32 v137, v12, -v13
    v_pk_fma_f32 v[28:29], v[28:29], v[26:27], v[52:53] op_sel:[1,1,0] op_sel_hi:[0,1,1] neg_lo:[1,0,0]
    v_cvt_pk_bf16_f32 v165, v30, v31
    v_pk_mul_f32 v[46:47], v[44:45], v[32:33] op_sel:[0,0] op_sel_hi:[1,0]
    v_pk_mul_f32 v[50:51], v[12:13], v[40:41] op_sel:[0,0] op_sel_hi:[1,0]
    v_cvt_pk_bf16_f32 v166, v28, v29
    v_pk_mul_f32 v[54:55], v[30:31], v[26:27] op_sel:[0,0] op_sel_hi:[1,0]
    v_pk_fma_f32 v[44:45], v[44:45], v[32:33], v[46:47] op_sel:[1,1,0] op_sel_hi:[0,1,1] neg_lo:[1,0,0]
    v_pk_fma_f32 v[56:57], v[12:13], v[40:41], v[50:51] op_sel:[1,1,0] op_sel_hi:[0,1,1] neg_lo:[1,0,0]
    v_pk_mul_f32 v[52:53], v[28:29], v[26:27] op_sel:[0,0] op_sel_hi:[1,0]
    v_pk_fma_f32 v[30:31], v[30:31], v[26:27], v[54:55] op_sel:[1,1,0] op_sel_hi:[0,1,1] neg_lo:[1,0,0]
    v_cvt_pk_bf16_f32 v131, v44, -v45
    v_cvt_pk_bf16_f32 v144, v56, -v57
    v_pk_fma_f32 v[28:29], v[28:29], v[26:27], v[52:53] op_sel:[1,1,0] op_sel_hi:[0,1,1] neg_lo:[1,0,0]
    v_cvt_pk_bf16_f32 v167, v30, v31
    v_pk_mul_f32 v[46:47], v[44:45], v[32:33] op_sel:[0,0] op_sel_hi:[1,0]
    v_pk_mul_f32 v[48:49], v[56:57], v[36:37] op_sel:[0,0] op_sel_hi:[1,0]
    v_cvt_pk_bf16_f32 v168, v28, v29
    v_pk_mul_f32 v[54:55], v[30:31], v[26:27] op_sel:[0,0] op_sel_hi:[1,0]
    v_pk_fma_f32 v[44:45], v[44:45], v[32:33], v[46:47] op_sel:[1,1,0] op_sel_hi:[0,1,1] neg_lo:[1,0,0]
    v_pk_fma_f32 v[14:15], v[56:57], v[36:37], v[48:49] op_sel:[1,1,0] op_sel_hi:[0,1,1] neg_lo:[1,0,0]
    v_pk_mul_f32 v[52:53], v[28:29], v[26:27] op_sel:[0,0] op_sel_hi:[1,0]
    v_pk_fma_f32 v[30:31], v[30:31], v[26:27], v[54:55] op_sel:[1,1,0] op_sel_hi:[0,1,1] neg_lo:[1,0,0]
    v_cvt_pk_bf16_f32 v136, v44, -v45
    v_cvt_pk_bf16_f32 v145, v14, -v15
    v_pk_fma_f32 v[28:29], v[28:29], v[26:27], v[52:53] op_sel:[1,1,0] op_sel_hi:[0,1,1] neg_lo:[1,0,0]
    v_cvt_pk_bf16_f32 v169, v30, v31
    v_pk_mul_f32 v[46:47], v[44:45], v[32:33] op_sel:[0,0] op_sel_hi:[1,0]
    v_pk_mul_f32 v[48:49], v[14:15], v[36:37] op_sel:[0,0] op_sel_hi:[1,0]
    v_cvt_pk_bf16_f32 v170, v28, v29
    v_pk_mul_f32 v[54:55], v[30:31], v[26:27] op_sel:[0,0] op_sel_hi:[1,0]
    v_pk_fma_f32 v[44:45], v[44:45], v[32:33], v[46:47] op_sel:[1,1,0] op_sel_hi:[0,1,1] neg_lo:[1,0,0]
    v_pk_fma_f32 v[14:15], v[14:15], v[36:37], v[48:49] op_sel:[1,1,0] op_sel_hi:[0,1,1] neg_lo:[1,0,0]
    v_pk_mul_f32 v[52:53], v[28:29], v[26:27] op_sel:[0,0] op_sel_hi:[1,0]
    v_pk_fma_f32 v[30:31], v[30:31], v[26:27], v[54:55] op_sel:[1,1,0] op_sel_hi:[0,1,1] neg_lo:[1,0,0]
    v_cvt_pk_bf16_f32 v133, v44, -v45
    v_cvt_pk_bf16_f32 v146, v14, -v15
    v_pk_fma_f32 v[28:29], v[28:29], v[26:27], v[52:53] op_sel:[1,1,0] op_sel_hi:[0,1,1] neg_lo:[1,0,0]
    v_cvt_pk_bf16_f32 v171, v30, v31
    v_pk_mul_f32 v[46:47], v[44:45], v[32:33] op_sel:[0,0] op_sel_hi:[1,0]
    v_pk_mul_f32 v[50:51], v[56:57], v[40:41] op_sel:[0,0] op_sel_hi:[1,0]
    v_cvt_pk_bf16_f32 v172, v28, v29
    v_pk_mul_f32 v[54:55], v[30:31], v[26:27] op_sel:[0,0] op_sel_hi:[1,0]
    v_pk_fma_f32 v[44:45], v[44:45], v[32:33], v[46:47] op_sel:[1,1,0] op_sel_hi:[0,1,1] neg_lo:[1,0,0]
    v_pk_fma_f32 v[58:59], v[56:57], v[40:41], v[50:51] op_sel:[1,1,0] op_sel_hi:[0,1,1] neg_lo:[1,0,0]
    v_pk_mul_f32 v[52:53], v[28:29], v[26:27] op_sel:[0,0] op_sel_hi:[1,0]
    v_pk_fma_f32 v[30:31], v[30:31], v[26:27], v[54:55] op_sel:[1,1,0] op_sel_hi:[0,1,1] neg_lo:[1,0,0]
    v_cvt_pk_bf16_f32 v134, v44, -v45
    v_cvt_pk_bf16_f32 v148, v58, -v59
    v_pk_fma_f32 v[28:29], v[28:29], v[26:27], v[52:53] op_sel:[1,1,0] op_sel_hi:[0,1,1] neg_lo:[1,0,0]
    v_cvt_pk_bf16_f32 v173, v30, v31
    v_pk_mul_f32 v[46:47], v[44:45], v[32:33] op_sel:[0,0] op_sel_hi:[1,0]
    v_pk_mul_f32 v[48:49], v[58:59], v[36:37] op_sel:[0,0] op_sel_hi:[1,0]
    v_cvt_pk_bf16_f32 v174, v28, v29
    v_pk_mul_f32 v[54:55], v[30:31], v[26:27] op_sel:[0,0] op_sel_hi:[1,0]
    v_pk_fma_f32 v[44:45], v[44:45], v[32:33], v[46:47] op_sel:[1,1,0] op_sel_hi:[0,1,1] neg_lo:[1,0,0]
    v_pk_fma_f32 v[14:15], v[58:59], v[36:37], v[48:49] op_sel:[1,1,0] op_sel_hi:[0,1,1] neg_lo:[1,0,0]
    v_pk_mul_f32 v[52:53], v[28:29], v[26:27] op_sel:[0,0] op_sel_hi:[1,0]
    v_pk_fma_f32 v[30:31], v[30:31], v[26:27], v[54:55] op_sel:[1,1,0] op_sel_hi:[0,1,1] neg_lo:[1,0,0]
    v_cvt_pk_bf16_f32 v135, v44, -v45
    v_cvt_pk_bf16_f32 v149, v14, -v15
    v_pk_fma_f32 v[28:29], v[28:29], v[26:27], v[52:53] op_sel:[1,1,0] op_sel_hi:[0,1,1] neg_lo:[1,0,0]
    v_cvt_pk_bf16_f32 v175, v30, v31
    v_pk_mul_f32 v[46:47], v[44:45], v[32:33] op_sel:[0,0] op_sel_hi:[1,0]
    v_pk_mul_f32 v[48:49], v[14:15], v[36:37] op_sel:[0,0] op_sel_hi:[1,0]
    v_cvt_pk_bf16_f32 v176, v28, v29
    v_pk_mul_f32 v[54:55], v[30:31], v[26:27] op_sel:[0,0] op_sel_hi:[1,0]
    v_pk_fma_f32 v[44:45], v[44:45], v[32:33], v[46:47] op_sel:[1,1,0] op_sel_hi:[0,1,1] neg_lo:[1,0,0]
    v_pk_fma_f32 v[14:15], v[14:15], v[36:37], v[48:49] op_sel:[1,1,0] op_sel_hi:[0,1,1] neg_lo:[1,0,0]
    v_pk_mul_f32 v[52:53], v[28:29], v[26:27] op_sel:[0,0] op_sel_hi:[1,0]
    v_pk_fma_f32 v[30:31], v[30:31], v[26:27], v[54:55] op_sel:[1,1,0] op_sel_hi:[0,1,1] neg_lo:[1,0,0]
    v_cvt_pk_bf16_f32 v140, v44, -v45
    v_cvt_pk_bf16_f32 v150, v14, -v15
    v_pk_fma_f32 v[28:29], v[28:29], v[26:27], v[52:53] op_sel:[1,1,0] op_sel_hi:[0,1,1] neg_lo:[1,0,0]
    v_cvt_pk_bf16_f32 v177, v30, v31
    v_pk_mul_f32 v[46:47], v[12:13], v[34:35] op_sel:[0,0] op_sel_hi:[1,0]
    v_pk_mul_f32 v[50:51], v[58:59], v[40:41] op_sel:[0,0] op_sel_hi:[1,0]
    v_cvt_pk_bf16_f32 v178, v28, v29
    v_pk_mul_f32 v[54:55], v[30:31], v[26:27] op_sel:[0,0] op_sel_hi:[1,0]
    v_pk_fma_f32 v[44:45], v[12:13], v[34:35], v[46:47] op_sel:[1,1,0] op_sel_hi:[0,1,1] neg_lo:[1,0,0]
    v_pk_fma_f32 v[56:57], v[58:59], v[40:41], v[50:51] op_sel:[1,1,0] op_sel_hi:[0,1,1] neg_lo:[1,0,0]
    v_pk_mul_f32 v[52:53], v[28:29], v[26:27] op_sel:[0,0] op_sel_hi:[1,0]
    v_pk_fma_f32 v[30:31], v[30:31], v[26:27], v[54:55] op_sel:[1,1,0] op_sel_hi:[0,1,1] neg_lo:[1,0,0]
    v_cvt_pk_bf16_f32 v138, v44, -v45
    v_cvt_pk_bf16_f32 v147, v56, -v57
    v_pk_fma_f32 v[28:29], v[28:29], v[26:27], v[52:53] op_sel:[1,1,0] op_sel_hi:[0,1,1] neg_lo:[1,0,0]
    v_cvt_pk_bf16_f32 v179, v30, v31
    v_pk_mul_f32 v[46:47], v[44:45], v[34:35] op_sel:[0,0] op_sel_hi:[1,0]
    v_pk_mul_f32 v[48:49], v[56:57], v[38:39] op_sel:[0,0] op_sel_hi:[1,0]
    v_cvt_pk_bf16_f32 v180, v28, v29
    v_pk_mul_f32 v[54:55], v[30:31], v[26:27] op_sel:[0,0] op_sel_hi:[1,0]
    v_pk_fma_f32 v[44:45], v[44:45], v[34:35], v[46:47] op_sel:[1,1,0] op_sel_hi:[0,1,1] neg_lo:[1,0,0]
    v_pk_fma_f32 v[14:15], v[56:57], v[38:39], v[48:49] op_sel:[1,1,0] op_sel_hi:[0,1,1] neg_lo:[1,0,0]
    v_pk_mul_f32 v[52:53], v[28:29], v[26:27] op_sel:[0,0] op_sel_hi:[1,0]
    v_pk_fma_f32 v[30:31], v[30:31], v[26:27], v[54:55] op_sel:[1,1,0] op_sel_hi:[0,1,1] neg_lo:[1,0,0]
    v_cvt_pk_bf16_f32 v139, v44, -v45
    v_cvt_pk_bf16_f32 v152, v14, -v15
    v_pk_fma_f32 v[28:29], v[28:29], v[26:27], v[52:53] op_sel:[1,1,0] op_sel_hi:[0,1,1] neg_lo:[1,0,0]
    v_cvt_pk_bf16_f32 v181, v30, v31
    v_pk_mul_f32 v[46:47], v[44:45], v[34:35] op_sel:[0,0] op_sel_hi:[1,0]
    v_pk_mul_f32 v[50:51], v[56:57], v[40:41] op_sel:[0,0] op_sel_hi:[1,0]
    v_cvt_pk_bf16_f32 v182, v28, v29
    v_pk_mul_f32 v[54:55], v[30:31], v[26:27] op_sel:[0,0] op_sel_hi:[1,0]
    v_pk_fma_f32 v[44:45], v[44:45], v[34:35], v[46:47] op_sel:[1,1,0] op_sel_hi:[0,1,1] neg_lo:[1,0,0]
    v_pk_fma_f32 v[58:59], v[56:57], v[40:41], v[50:51] op_sel:[1,1,0] op_sel_hi:[0,1,1] neg_lo:[1,0,0]
    v_pk_mul_f32 v[52:53], v[28:29], v[26:27] op_sel:[0,0] op_sel_hi:[1,0]
    v_pk_fma_f32 v[30:31], v[30:31], v[26:27], v[54:55] op_sel:[1,1,0] op_sel_hi:[0,1,1] neg_lo:[1,0,0]
    v_cvt_pk_bf16_f32 v142, v44, -v45
    v_cvt_pk_bf16_f32 v151, v58, -v59
    v_pk_fma_f32 v[28:29], v[28:29], v[26:27], v[52:53] op_sel:[1,1,0] op_sel_hi:[0,1,1] neg_lo:[1,0,0]
    v_cvt_pk_bf16_f32 v183, v30, v31
    v_pk_mul_f32 v[46:47], v[44:45], v[34:35] op_sel:[0,0] op_sel_hi:[1,0]
    v_pk_mul_f32 v[48:49], v[58:59], v[38:39] op_sel:[0,0] op_sel_hi:[1,0]
    v_cvt_pk_bf16_f32 v184, v28, v29
    v_pk_mul_f32 v[54:55], v[30:31], v[26:27] op_sel:[0,0] op_sel_hi:[1,0]
    v_pk_fma_f32 v[44:45], v[44:45], v[34:35], v[46:47] op_sel:[1,1,0] op_sel_hi:[0,1,1] neg_lo:[1,0,0]
    v_pk_fma_f32 v[14:15], v[58:59], v[38:39], v[48:49] op_sel:[1,1,0] op_sel_hi:[0,1,1] neg_lo:[1,0,0]
    v_pk_mul_f32 v[52:53], v[28:29], v[26:27] op_sel:[0,0] op_sel_hi:[1,0]
    v_pk_fma_f32 v[30:31], v[30:31], v[26:27], v[54:55] op_sel:[1,1,0] op_sel_hi:[0,1,1] neg_lo:[1,0,0]
    v_cvt_pk_bf16_f32 v143, v44, -v45
    v_cvt_pk_bf16_f32 v156, v14, -v15
    v_pk_fma_f32 v[28:29], v[28:29], v[26:27], v[52:53] op_sel:[1,1,0] op_sel_hi:[0,1,1] neg_lo:[1,0,0]
    v_cvt_pk_bf16_f32 v185, v30, v31
    v_pk_mul_f32 v[50:51], v[58:59], v[40:41] op_sel:[0,0] op_sel_hi:[1,0]
    v_cvt_pk_bf16_f32 v186, v28, v29
    v_pk_mul_f32 v[54:55], v[30:31], v[26:27] op_sel:[0,0] op_sel_hi:[1,0]
    v_pk_fma_f32 v[56:57], v[58:59], v[40:41], v[50:51] op_sel:[1,1,0] op_sel_hi:[0,1,1] neg_lo:[1,0,0]
    v_pk_mul_f32 v[52:53], v[28:29], v[26:27] op_sel:[0,0] op_sel_hi:[1,0]
    v_pk_fma_f32 v[30:31], v[30:31], v[26:27], v[54:55] op_sel:[1,1,0] op_sel_hi:[0,1,1] neg_lo:[1,0,0]
    v_cvt_pk_bf16_f32 v153, v56, -v57
    v_pk_fma_f32 v[28:29], v[28:29], v[26:27], v[52:53] op_sel:[1,1,0] op_sel_hi:[0,1,1] neg_lo:[1,0,0]
    v_cvt_pk_bf16_f32 v187, v30, v31
    v_pk_mul_f32 v[48:49], v[56:57], v[38:39] op_sel:[0,0] op_sel_hi:[1,0]
    v_cvt_pk_bf16_f32 v188, v28, v29
    v_pk_mul_f32 v[54:55], v[30:31], v[26:27] op_sel:[0,0] op_sel_hi:[1,0]
    v_pk_fma_f32 v[14:15], v[56:57], v[38:39], v[48:49] op_sel:[1,1,0] op_sel_hi:[0,1,1] neg_lo:[1,0,0]
    v_pk_mul_f32 v[52:53], v[28:29], v[26:27] op_sel:[0,0] op_sel_hi:[1,0]
    v_pk_fma_f32 v[30:31], v[30:31], v[26:27], v[54:55] op_sel:[1,1,0] op_sel_hi:[0,1,1] neg_lo:[1,0,0]
    v_cvt_pk_bf16_f32 v154, v14, -v15
    v_pk_fma_f32 v[28:29], v[28:29], v[26:27], v[52:53] op_sel:[1,1,0] op_sel_hi:[0,1,1] neg_lo:[1,0,0]
    v_cvt_pk_bf16_f32 v189, v30, v31
    v_pk_mul_f32 v[50:51], v[56:57], v[40:41] op_sel:[0,0] op_sel_hi:[1,0]
    v_cvt_pk_bf16_f32 v190, v28, v29
    v_pk_mul_f32 v[54:55], v[30:31], v[26:27] op_sel:[0,0] op_sel_hi:[1,0]
    v_pk_fma_f32 v[58:59], v[56:57], v[40:41], v[50:51] op_sel:[1,1,0] op_sel_hi:[0,1,1] neg_lo:[1,0,0]
    v_pk_fma_f32 v[30:31], v[30:31], v[26:27], v[54:55] op_sel:[1,1,0] op_sel_hi:[0,1,1] neg_lo:[1,0,0]
    v_cvt_pk_bf16_f32 v157, v58, -v59
    v_cvt_pk_bf16_f32 v191, v30, v31
    v_pk_mul_f32 v[48:49], v[58:59], v[38:39] op_sel:[0,0] op_sel_hi:[1,0]
    v_pk_fma_f32 v[14:15], v[58:59], v[38:39], v[48:49] op_sel:[1,1,0] op_sel_hi:[0,1,1] neg_lo:[1,0,0]
    v_cvt_pk_bf16_f32 v158, v14, -v15
    s_branch L_t1
L_ldone:
    s_setprio 1
    s_call_b64 s[64:65], L_setup
    s_waitcnt lgkmcnt(0)
    s_mul_i32 s50, s50, 0x9e3779b1
    s_add_u32 s50, s50, 0x7f4a7c15
    s_xor_b32 s51, s51, s50
    s_mul_i32 s51, s51, 0x85ebca6b
    s_add_u32 s51, s51, 0x2545f491
    v_mov_b32 v244, s50
    v_mov_b32 v245, s51
L_t1:
    s_mov_b32 s52, s42
    s_and_b32 s53, s43, 0xffff
    s_mov_b32 s54, 524288
    s_mov_b32 s55, 0x20000
    v_mov_b64 v[36:37], 0
    v_lshlrev_b32 v31, 3, v1
    v_add_u32 v31, 69632, v31
L_concat_heads__ssm_conv_s4__grouped_kv_mqa__prompt_kernel_lw_3:
    ds_read_b32 v30, v10 offset:12
    s_waitcnt lgkmcnt(0)
    v_cmp_gt_u32 vcc, 4, v30
    s_cbranch_vccnz L_concat_heads__ssm_conv_s4__grouped_kv_mqa__prompt_kernel_lwr_4
    s_mov_b32 exec_hi, 0x0fffffff
    ds_write_b64 v31, v[36:37]
    ds_write_b64 v31, v[36:37] offset:4576
    s_mov_b64 exec, -1
    s_sub_u32 s10, s3, 5
    s_cmp_gt_u32 s10, 1
    s_cbranch_scc1 L_nokgen
    s_mul_i32 s13, s14, 8704
    s_add_u32 s13, s13, 78848
    v_lshl_add_u32 v26, v1, 2, s13
    v_and_b32 v11, 31, v1
    v_mul_u32_u24 v12, 272, v11
    v_lshl_add_u32 v12, v5, 4, v12
    v_add_u32 v27, s13, v12
    ds_write_b32 v26, v64 offset:0
    ds_write_b32 v26, v65 offset:272
    ds_write_b32 v26, v66 offset:544
    ds_write_b32 v26, v67 offset:816
    ds_write_b32 v26, v72 offset:1088
    ds_write_b32 v26, v69 offset:1360
    ds_write_b32 v26, v70 offset:1632
    ds_write_b32 v26, v71 offset:1904
    ds_write_b32 v26, v72 offset:2176
    ds_write_b32 v26, v73 offset:2448
    ds_write_b32 v26, v74 offset:2720
    ds_write_b32 v26, v75 offset:2992
    ds_write_b32 v26, v76 offset:3264
    ds_write_b32 v26, v75 offset:3536
    ds_write_b32 v26, v78 offset:3808
    ds_write_b32 v26, v79 offset:4080
    ds_write_b32 v26, v80 offset:4352
    ds_write_b32 v26, v81 offset:4624
    ds_write_b32 v26, v82 offset:4896
    ds_write_b32 v26, v83 offset:5168
    ds_write_b32 v26, v84 offset:5440
    ds_write_b32 v26, v85 offset:5712
    ds_write_b32 v26, v86 offset:5984
    ds_write_b32 v26, v87 offset:6256
    ds_write_b32 v26, v88 offset:6528
    ds_write_b32 v26, v89 offset:6800
    ds_write_b32 v26, v90 offset:7072
    ds_write_b32 v26, v92 offset:7616
    ds_write_b32 v26, v93 offset:7888
    ds_write_b32 v26, v94 offset:8160
    ds_read_b128 v[64:67], v27 offset:0
    ds_read_b128 v[68:71], v27 offset:32
    ds_read_b128 v[72:75], v27 offset:64
    ds_read_b128 v[76:79], v27 offset:96
    ds_read_b128 v[80:83], v27 offset:128
    ds_read_b128 v[84:87], v27 offset:160
    ds_read_b128 v[88:91], v27 offset:192
    ds_read_b128 v[92:95], v27 offset:224
    ds_write_b32 v26, v96 offset:0
    ds_write_b32 v26, v97 offset:272
    ds_write_b32 v26, v98 offset:544
    ds_write_b32 v26, v99 offset:816
    ds_write_b32 v26, v100 offset:1088
    ds_write_b32 v26, v101 offset:1360
    ds_write_b32 v26, v102 offset:1632
    ds_write_b32 v26, v103 offset:1904
    ds_write_b32 v26, v104 offset:2176
    ds_write_b32 v26, v105 offset:2448
    ds_write_b32 v26, v106 offset:2720
    ds_write_b32 v26, v107 offset:2992
    ds_write_b32 v26, v108 offset:3264
    ds_write_b32 v26, v109 offset:3536
    ds_write_b32 v26, v110 offset:3808
    ds_write_b32 v26, v111 offset:4080
    ds_write_b32 v26, v112 offset:4352
    ds_write_b32 v26, v113 offset:4624
    ds_write_b32 v26, v114 offset:4896
    ds_write_b32 v26, v115 offset:5168
    ds_write_b32 v26, v116 offset:5440
    ds_write_b32 v26, v117 offset:5712
    ds_write_b32 v26, v118 offset:5984
    ds_write_b32 v26, v119 offset:6256
    ds_write_b32 v26, v120 offset:6528
    ds_write_b32 v26, v121 offset:6800
    ds_write_b32 v26, v122 offset:7072
    ds_write_b32 v26, v123 offset:7344
    ds_write_b32 v26, v124 offset:7616
    ds_write_b32 v26, v125 offset:7888
    ds_write_b32 v26, v126 offset:8160
    ds_write_b32 v26, v127 offset:8432
    ds_read_b128 v[96:99], v27 offset:0
    ds_read_b128 v[100:103], v27 offset:32
    ds_read_b128 v[104:107], v27 offset:64
    ds_read_b128 v[108:111], v27 offset:96
    ds_read_b128 v[112:115], v27 offset:128
    ds_read_b128 v[116:119], v27 offset:160
    ds_read_b128 v[120:123], v27 offset:192
    ds_read_b128 v[124:127], v27 offset:224
    s_waitcnt lgkmcnt(7)
    v_mfma_f32_32x32x16_bf16 v[48:63], v[64:67], v[96:99], 0
    s_waitcnt lgkmcnt(6)
    v_mfma_f32_32x32x16_bf16 v[48:63], v[68:71], v[100:103], v[48:63]
    s_waitcnt lgkmcnt(5)
    v_mfma_f32_32x32x16_bf16 v[48:63], v[72:75], v[104:107], v[48:63]
    s_waitcnt lgkmcnt(4)
    v_mfma_f32_32x32x16_bf16 v[48:63], v[76:79], v[108:111], v[48:63]
    s_waitcnt lgkmcnt(3)
    v_mfma_f32_32x32x16_bf16 v[48:63], v[80:83], v[112:115], v[48:63]
    s_waitcnt lgkmcnt(2)
    v_mfma_f32_32x32x16_bf16 v[48:63], v[84:87], v[116:119], v[48:63]
    s_waitcnt lgkmcnt(1)
    v_mfma_f32_32x32x16_bf16 v[48:63], v[88:91], v[120:123], v[48:63]
    s_waitcnt lgkmcnt(0)
    v_mfma_f32_32x32x16_bf16 v[48:63], v[92:95], v[124:127], v[48:63]
    ds_write_b32 v26, v128 offset:0
    ds_write_b32 v26, v129 offset:272
    ds_write_b32 v26, v130 offset:544
    ds_write_b32 v26, v131 offset:816
    ds_write_b32 v26, v136 offset:1088
    ds_write_b32 v26, v133 offset:1360
    ds_write_b32 v26, v134 offset:1632
    ds_write_b32 v26, v135 offset:1904
    ds_write_b32 v26, v136 offset:2176
    ds_write_b32 v26, v137 offset:2448
    ds_write_b32 v26, v138 offset:2720
    ds_write_b32 v26, v139 offset:2992
    ds_write_b32 v26, v140 offset:3264
    ds_write_b32 v26, v139 offset:3536
    ds_write_b32 v26, v142 offset:3808
    ds_write_b32 v26, v143 offset:4080
    ds_write_b32 v26, v144 offset:4352
    ds_write_b32 v26, v145 offset:4624
    ds_write_b32 v26, v146 offset:4896
    ds_write_b32 v26, v147 offset:5168
    ds_write_b32 v26, v148 offset:5440
    ds_write_b32 v26, v149 offset:5712
    ds_write_b32 v26, v150 offset:5984
    ds_write_b32 v26, v151 offset:6256
    ds_write_b32 v26, v152 offset:6528
    ds_write_b32 v26, v153 offset:6800
    ds_write_b32 v26, v154 offset:7072
    ds_write_b32 v26, v156 offset:7616
    ds_write_b32 v26, v157 offset:7888
    ds_write_b32 v26, v158 offset:8160
    ds_read_b128 v[128:131], v27 offset:0
    ds_read_b128 v[132:135], v27 offset:32
    ds_read_b128 v[136:139], v27 offset:64
    ds_read_b128 v[140:143], v27 offset:96
    ds_read_b128 v[144:147], v27 offset:128
    ds_read_b128 v[148:151], v27 offset:160
    ds_read_b128 v[152:155], v27 offset:192
    ds_read_b128 v[156:159], v27 offset:224
    ds_write_b32 v26, v160 offset:0
    ds_write_b32 v26, v161 offset:272
    ds_write_b32 v26, v162 offset:544
    ds_write_b32 v26, v163 offset:816
    ds_write_b32 v26, v164 offset:1088
    ds_write_b32 v26, v165 offset:1360
    ds_write_b32 v26, v166 offset:1632
    ds_write_b32 v26, v167 offset:1904
    ds_write_b32 v26, v168 offset:2176
    ds_write_b32 v26, v169 offset:2448
    ds_write_b32 v26, v170 offset:2720
    ds_write_b32 v26, v171 offset:2992
    ds_write_b32 v26, v172 offset:3264
    ds_write_b32 v26, v173 offset:3536
    ds_write_b32 v26, v174 offset:3808
    ds_write_b32 v26, v175 offset:4080
    ds_write_b32 v26, v176 offset:4352
    ds_write_b32 v26, v177 offset:4624
    ds_write_b32 v26, v178 offset:4896
    ds_write_b32 v26, v179 offset:5168
    ds_write_b32 v26, v180 offset:5440
    ds_write_b32 v26, v181 offset:5712
    ds_write_b32 v26, v182 offset:5984
    ds_write_b32 v26, v183 offset:6256
    ds_write_b32 v26, v184 offset:6528
    ds_write_b32 v26, v185 offset:6800
    ds_write_b32 v26, v186 offset:7072
    ds_write_b32 v26, v187 offset:7344
    ds_write_b32 v26, v188 offset:7616
    ds_write_b32 v26, v189 offset:7888
    ds_write_b32 v26, v190 offset:8160
    ds_write_b32 v26, v191 offset:8432
    ds_read_b128 v[160:163], v27 offset:0
    ds_read_b128 v[164:167], v27 offset:32
    ds_read_b128 v[168:171], v27 offset:64
    ds_read_b128 v[172:175], v27 offset:96
    ds_read_b128 v[176:179], v27 offset:128
    ds_read_b128 v[180:183], v27 offset:160
    ds_read_b128 v[184:187], v27 offset:192
    ds_read_b128 v[188:191], v27 offset:224
    s_waitcnt lgkmcnt(7)
    v_mfma_f32_32x32x16_bf16 v[48:63], v[128:131], v[160:163], v[48:63]
    s_waitcnt lgkmcnt(6)
    v_mfma_f32_32x32x16_bf16 v[48:63], v[132:135], v[164:167], v[48:63]
    s_waitcnt lgkmcnt(5)
    v_mfma_f32_32x32x16_bf16 v[48:63], v[136:139], v[168:171], v[48:63]
    s_waitcnt lgkmcnt(4)
    v_mfma_f32_32x32x16_bf16 v[48:63], v[140:143], v[172:175], v[48:63]
    s_waitcnt lgkmcnt(3)
    v_mfma_f32_32x32x16_bf16 v[48:63], v[144:147], v[176:179], v[48:63]
    s_waitcnt lgkmcnt(2)
    v_mfma_f32_32x32x16_bf16 v[48:63], v[148:151], v[180:183], v[48:63]
    s_waitcnt lgkmcnt(1)
    v_mfma_f32_32x32x16_bf16 v[48:63], v[152:155], v[184:187], v[48:63]
    s_waitcnt lgkmcnt(0)
    v_mfma_f32_32x32x16_bf16 v[48:63], v[156:159], v[188:191], v[48:63]
    s_mul_i32 s13, s14, 8320
    s_add_u32 s13, s13, 131072
    v_lshlrev_b32 v12, 4, v11
    v_sub_u32 v12, s13, v12
    v_lshlrev_b32 v13, 3, v5
    v_sub_u32 v26, v12, v13
    v_lshlrev_b32 v13, 9, v5
    v_sub_u32 v27, v12, v13
    v_lshl_add_u32 v28, v1, 2, s13
    v_and_b32 v15, 1, v1
    v_cmp_eq_u32 vcc, 0, v15
    v_mov_b32 v13, 0
    s_nop 0
    v_cndmask_b32 v14, v60, v59, vcc
    v_cndmask_b32 v15, v62, v61, vcc
    v_cvt_pk_bf16_f32 v64, v52, v51
    v_cvt_pk_bf16_f32 v65, v50, v49
    v_cvt_pk_bf16_f32 v66, v51, v50
    v_cvt_pk_bf16_f32 v67, v49, v48
    ds_write_b64 v26, v[64:65] offset:4088
    ds_write_b64 v26, v[66:67] offset:8248
    v_cvt_pk_bf16_f32 v68, v55, v55
    v_cvt_pk_bf16_f32 v69, v54, v53
    v_cvt_pk_bf16_f32 v70, v55, v54
    v_cvt_pk_bf16_f32 v71, v53, v53
    ds_write_b64 v26, v[68:69] offset:3576
    ds_write_b64 v26, v[70:71] offset:7736
    v_cvt_pk_bf16_f32 v72, v58, v58
    v_cvt_pk_bf16_f32 v73, v58, v57
    v_cvt_pk_bf16_f32 v74, v57, v57
    v_cvt_pk_bf16_f32 v75, v56, v56
    v_cvt_pk_bf16_f32 v76, v58, v58
    v_cvt_pk_bf16_f32 v77, v57, v57
    v_cvt_pk_bf16_f32 v78, v57, v56
    v_cvt_pk_bf16_f32 v79, v56, v56
    ds_write_b128 v27, v[72:75] offset:3056
    ds_write_b128 v27, v[76:79] offset:7216
    v_cvt_pk_bf16_f32 v80, v60, v60
    v_cvt_pk_bf16_f32 v81, v60, v60
    v_cvt_pk_bf16_f32 v82, v14, v59
    v_cvt_pk_bf16_f32 v83, v59, v59
    v_cvt_pk_bf16_f32 v84, v60, v60
    v_cvt_pk_bf16_f32 v85, v60, v14
    v_cvt_pk_bf16_f32 v86, v59, v59
    v_cvt_pk_bf16_f32 v87, v59, v59
    ds_write_b128 v27, v[80:83] offset:2032
    ds_write_b128 v27, v[84:87] offset:6192
    v_cvt_pk_bf16_f32 v88, v62, v62
    v_cvt_pk_bf16_f32 v89, v62, v62
    v_cvt_pk_bf16_f32 v90, v15, v61
    v_cvt_pk_bf16_f32 v91, v61, v61
    v_cvt_pk_bf16_f32 v92, v62, v62
    v_cvt_pk_bf16_f32 v93, v62, v15
    v_cvt_pk_bf16_f32 v94, v61, v61
    v_cvt_pk_bf16_f32 v95, v61, v61
    ds_write_b128 v27, v[88:91] offset:1008
    ds_write_b128 v27, v[92:95] offset:5168
    v_cvt_pk_bf16_f32 v12, v48, 0
    v_cmp_eq_u32 vcc, 0, v1
    s_nop 1
    v_cndmask_b32 v12, v13, v12, vcc
    s_mov_b64 exec, 0xff
    ds_write_b32 v28, v12 offset:4096
    ds_write_b32 v28, v13 offset:8256
    s_mov_b64 exec, -1
L_nokgen:
    s_mov_b32 s10, 0x05040100
    s_mov_b32 s11, 0x07060302
L_concat_heads__ssm_conv_s4__grouped_kv_mqa__prompt_kernel_lw_5:
    ds_read_b32 v30, v10 offset:4
    s_waitcnt lgkmcnt(0)
    v_cmp_gt_u32 vcc, 4, v30
    s_cbranch_vccnz L_concat_heads__ssm_conv_s4__grouped_kv_mqa__prompt_kernel_lwr_6
    global_load_dword v24, v228, s[32:33]
    global_load_dword v16, v227, s[16:17] offset:-4096
    global_load_dword v17, v227, s[16:17] offset:-3072
    global_load_dword v18, v227, s[16:17] offset:-2048
    global_load_dword v19, v227, s[16:17] offset:-1024
    global_load_dword v20, v227, s[16:17] offset:0
    global_load_dword v21, v227, s[16:17] offset:1024
    global_load_dword v22, v227, s[16:17] offset:2048
    global_load_dword v23, v227, s[16:17] offset:3072
    s_waitcnt vmcnt(0)
    v_perm_b32 v32, v17, v16, s10
    v_perm_b32 v36, v17, v16, s11
    v_perm_b32 v33, v19, v18, s10
    v_perm_b32 v37, v19, v18, s11
    v_perm_b32 v34, v21, v20, s10
    v_perm_b32 v38, v21, v20, s11
    v_perm_b32 v35, v23, v22, s10
    v_perm_b32 v39, v23, v22, s11
    global_store_dwordx4 v208, v[32:35], s[48:49] offset:-2048 sc1
    global_store_dwordx4 v208, v[36:39], s[48:49] offset:2048 sc1
    v_lshlrev_b32 v26, 16, v24
    v_and_b32 v27, 0xffff0000, v24
    v_lshlrev_b32 v12, 16, v16
    v_and_b32 v13, 0xffff0000, v16
    v_lshlrev_b32 v14, 16, v17
    v_and_b32 v15, 0xffff0000, v17
    v_pk_mul_f32 v[12:13], v[12:13], v[26:27]
    v_pk_mul_f32 v[14:15], v[14:15], v[26:27]
    v_cvt_pk_bf16_f32 v200, v12, v13
    v_cvt_pk_bf16_f32 v201, v14, v15
    v_lshlrev_b32 v12, 16, v18
    v_and_b32 v13, 0xffff0000, v18
    v_lshlrev_b32 v14, 16, v19
    v_and_b32 v15, 0xffff0000, v19
    v_pk_mul_f32 v[12:13], v[12:13], v[26:27]
    v_pk_mul_f32 v[14:15], v[14:15], v[26:27]
    v_cvt_pk_bf16_f32 v202, v12, v13
    v_cvt_pk_bf16_f32 v203, v14, v15
    v_lshlrev_b32 v12, 16, v20
    v_and_b32 v13, 0xffff0000, v20
    v_lshlrev_b32 v14, 16, v21
    v_and_b32 v15, 0xffff0000, v21
    v_pk_mul_f32 v[12:13], v[12:13], v[26:27]
    v_pk_mul_f32 v[14:15], v[14:15], v[26:27]
    v_cvt_pk_bf16_f32 v204, v12, v13
    v_cvt_pk_bf16_f32 v205, v14, v15
    v_lshlrev_b32 v12, 16, v22
    v_and_b32 v13, 0xffff0000, v22
    v_lshlrev_b32 v14, 16, v23
    v_and_b32 v15, 0xffff0000, v23
    v_pk_mul_f32 v[12:13], v[12:13], v[26:27]
    v_pk_mul_f32 v[14:15], v[14:15], v[26:27]
    v_cvt_pk_bf16_f32 v206, v12, v13
    v_cvt_pk_bf16_f32 v207, v14, v15
    v_add_u32 v208, 2097152, v208
    s_waitcnt vmcnt(0)
    s_mov_b64 exec, 1
    global_store_dwordx2 v226, v[244:245], s[48:49] sc1
    s_mov_b64 exec, -1
    s_sleep 12
L_concat_heads__ssm_conv_s4__grouped_kv_mqa__prompt_kernel_gp_7:
    global_load_dwordx2 v[26:27], v211, s[48:49] sc1
    s_waitcnt vmcnt(0)
    v_cmp_ne_u64 vcc, s[50:51], v[26:27]
    s_cbranch_vccnz L_concat_heads__ssm_conv_s4__grouped_kv_mqa__prompt_kernel_gpr_8
    global_load_dwordx4 v[16:19], v212, s[48:49] sc1
    global_load_dwordx4 v[20:23], v212, s[48:49] offset:1024 sc1
    v_add_u32 v212, 2097152, v212
    s_waitcnt vmcnt(0)
    ds_write_b128 v213, v[16:19]
    ds_write_b128 v213, v[20:23] offset:1024
    s_waitcnt lgkmcnt(0)
    s_mov_b64 exec, 1
    ds_add_u32 v10, v9 offset:16
    s_mov_b64 exec, -1
L_concat_heads__ssm_conv_s4__grouped_kv_mqa__prompt_kernel_lw_9:
    ds_read_b32 v30, v10 offset:16
    s_waitcnt lgkmcnt(0)
    v_cmp_gt_u32 vcc, 4, v30
    s_cbranch_vccnz L_concat_heads__ssm_conv_s4__grouped_kv_mqa__prompt_kernel_lwr_10
    s_lshl1_add_u32 s12, s6, s15
    s_lshl1_add_u32 s12, s12, s14
    s_lshl_b32 s12, s12, 13
    s_add_u32 s12, s12, 10485760
    v_lshl_add_u32 v25, v1, 7, s12
    global_load_dword v25, v25, s[48:49] sc1
    ds_read_b128 v[96:99], v214 offset:192
    ds_read2_b32 v[64:65], v215 offset0:176 offset1:177
    ds_read2_b32 v[66:67], v215 offset0:178 offset1:179
    ds_read_b128 v[100:103], v214 offset:704
    ds_read2_b32 v[68:69], v215 offset0:48 offset1:49
    ds_read2_b32 v[70:71], v215 offset0:50 offset1:51
    ds_read_b128 v[104:107], v214 offset:1216
    ds_read2_b32 v[72:73], v216 offset0:176 offset1:177
    ds_read2_b32 v[74:75], v216 offset0:178 offset1:179
    ds_read_b128 v[108:111], v214 offset:1728
    ds_read2_b32 v[76:77], v216 offset0:48 offset1:49
    ds_read2_b32 v[78:79], v216 offset0:50 offset1:51
    ds_read_b128 v[112:115], v214 offset:2240
    ds_read2_b32 v[80:81], v217 offset0:176 offset1:177
    ds_read2_b32 v[82:83], v217 offset0:178 offset1:179
    ds_read_b128 v[116:119], v214 offset:2752
    ds_read2_b32 v[84:85], v217 offset0:48 offset1:49
    ds_read2_b32 v[86:87], v217 offset0:50 offset1:51
    ds_read_b128 v[120:123], v214 offset:3264
    ds_read2_b32 v[88:89], v218 offset0:176 offset1:177
    ds_read2_b32 v[90:91], v218 offset0:178 offset1:179
    ds_read_b128 v[124:127], v214 offset:3776
    ds_read2_b32 v[92:93], v218 offset0:48 offset1:49
    ds_read2_b32 v[94:95], v218 offset0:50 offset1:51
    s_waitcnt lgkmcnt(0)
    v_mfma_f32_16x16x32_bf16 v[32:35], v[64:67], v[96:99], 0
    ds_read_b128 v[160:163], v214 offset:128
    v_mfma_f32_16x16x32_bf16 v[36:39], v[64:67], v[100:103], 0
    ds_read2_b32 v[128:129], v215 offset0:160 offset1:161
    v_mfma_f32_16x16x32_bf16 v[40:43], v[64:67], v[104:107], 0
    ds_read2_b32 v[130:131], v215 offset0:162 offset1:163
    v_mfma_f32_16x16x32_bf16 v[44:47], v[64:67], v[108:111], 0
    ds_read_b128 v[164:167], v214 offset:640
    v_mfma_f32_16x16x32_bf16 v[48:51], v[64:67], v[112:115], 0
    ds_read2_b32 v[132:133], v215 offset0:32 offset1:33
    v_mfma_f32_16x16x32_bf16 v[52:55], v[64:67], v[116:119], 0
    ds_read2_b32 v[134:135], v215 offset0:34 offset1:35
    v_mfma_f32_16x16x32_bf16 v[56:59], v[64:67], v[120:123], 0
    ds_read_b128 v[168:171], v214 offset:1152
    v_mfma_f32_16x16x32_bf16 v[60:63], v[64:67], v[124:127], 0
    ds_read2_b32 v[136:137], v216 offset0:160 offset1:161
    v_mfma_f32_16x16x32_bf16 v[36:39], v[68:71], v[96:99], v[36:39]
    ds_read2_b32 v[138:139], v216 offset0:162 offset1:163
    v_mfma_f32_16x16x32_bf16 v[40:43], v[68:71], v[100:103], v[40:43]
    ds_read_b128 v[172:175], v214 offset:1664
    v_mfma_f32_16x16x32_bf16 v[44:47], v[68:71], v[104:107], v[44:47]
    ds_read2_b32 v[140:141], v216 offset0:32 offset1:33
    v_mfma_f32_16x16x32_bf16 v[48:51], v[68:71], v[108:111], v[48:51]
    ds_read2_b32 v[142:143], v216 offset0:34 offset1:35
    v_mfma_f32_16x16x32_bf16 v[52:55], v[68:71], v[112:115], v[52:55]
    ds_read_b128 v[176:179], v214 offset:2176
    v_mfma_f32_16x16x32_bf16 v[56:59], v[68:71], v[116:119], v[56:59]
    ds_read2_b32 v[144:145], v217 offset0:160 offset1:161
    v_mfma_f32_16x16x32_bf16 v[60:63], v[68:71], v[120:123], v[60:63]
    ds_read2_b32 v[146:147], v217 offset0:162 offset1:163
    v_mfma_f32_16x16x32_bf16 v[40:43], v[72:75], v[96:99], v[40:43]
    ds_read_b128 v[180:183], v214 offset:2688
    v_mfma_f32_16x16x32_bf16 v[44:47], v[72:75], v[100:103], v[44:47]
    ds_read2_b32 v[148:149], v217 offset0:32 offset1:33
    v_mfma_f32_16x16x32_bf16 v[48:51], v[72:75], v[104:107], v[48:51]
    ds_read2_b32 v[150:151], v217 offset0:34 offset1:35
    v_mfma_f32_16x16x32_bf16 v[52:55], v[72:75], v[108:111], v[52:55]
    ds_read_b128 v[184:187], v214 offset:3200
    v_mfma_f32_16x16x32_bf16 v[56:59], v[72:75], v[112:115], v[56:59]
    ds_read2_b32 v[152:153], v218 offset0:160 offset1:161
    v_mfma_f32_16x16x32_bf16 v[60:63], v[72:75], v[116:119], v[60:63]
    ds_read2_b32 v[154:155], v218 offset0:162 offset1:163
    v_mfma_f32_16x16x32_bf16 v[44:47], v[76:79], v[96:99], v[44:47]
    ds_read_b128 v[188:191], v214 offset:3712
    v_mfma_f32_16x16x32_bf16 v[48:51], v[76:79], v[100:103], v[48:51]
    ds_read2_b32 v[156:157], v218 offset0:32 offset1:33
    v_mfma_f32_16x16x32_bf16 v[52:55], v[76:79], v[104:107], v[52:55]
    ds_read2_b32 v[158:159], v218 offset0:34 offset1:35
    v_mfma_f32_16x16x32_bf16 v[56:59], v[76:79], v[108:111], v[56:59]
    v_mfma_f32_16x16x32_bf16 v[60:63], v[76:79], v[112:115], v[60:63]
    v_mfma_f32_16x16x32_bf16 v[48:51], v[80:83], v[96:99], v[48:51]
    v_mfma_f32_16x16x32_bf16 v[52:55], v[80:83], v[100:103], v[52:55]
    v_mfma_f32_16x16x32_bf16 v[56:59], v[80:83], v[104:107], v[56:59]
    v_mfma_f32_16x16x32_bf16 v[60:63], v[80:83], v[108:111], v[60:63]
    v_mfma_f32_16x16x32_bf16 v[52:55], v[84:87], v[96:99], v[52:55]
    v_mfma_f32_16x16x32_bf16 v[56:59], v[84:87], v[100:103], v[56:59]
    v_mfma_f32_16x16x32_bf16 v[60:63], v[84:87], v[104:107], v[60:63]
    v_mfma_f32_16x16x32_bf16 v[56:59], v[88:91], v[96:99], v[56:59]
    v_mfma_f32_16x16x32_bf16 v[60:63], v[88:91], v[100:103], v[60:63]
    v_mfma_f32_16x16x32_bf16 v[60:63], v[92:95], v[96:99], v[60:63]
    s_waitcnt lgkmcnt(0)
    v_mfma_f32_16x16x32_bf16 v[32:35], v[128:131], v[160:163], v[32:35]
    ds_read_b128 v[96:99], v214 offset:64
    v_mfma_f32_16x16x32_bf16 v[36:39], v[128:131], v[164:167], v[36:39]
    ds_read2_b32 v[64:65], v215 offset0:144 offset1:145
    v_mfma_f32_16x16x32_bf16 v[40:43], v[128:131], v[168:171], v[40:43]
    ds_read2_b32 v[66:67], v215 offset0:146 offset1:147
    v_mfma_f32_16x16x32_bf16 v[44:47], v[128:131], v[172:175], v[44:47]
    ds_read_b128 v[100:103], v214 offset:576
    v_mfma_f32_16x16x32_bf16 v[48:51], v[128:131], v[176:179], v[48:51]
    ds_read2_b32 v[68:69], v215 offset0:16 offset1:17
    v_mfma_f32_16x16x32_bf16 v[52:55], v[128:131], v[180:183], v[52:55]
    ds_read2_b32 v[70:71], v215 offset0:18 offset1:19
    v_mfma_f32_16x16x32_bf16 v[56:59], v[128:131], v[184:187], v[56:59]
    ds_read_b128 v[104:107], v214 offset:1088
    v_mfma_f32_16x16x32_bf16 v[60:63], v[128:131], v[188:191], v[60:63]
    ds_read2_b32 v[72:73], v216 offset0:144 offset1:145
    v_mfma_f32_16x16x32_bf16 v[36:39], v[132:135], v[160:163], v[36:39]
    ds_read2_b32 v[74:75], v216 offset0:146 offset1:147
    v_mfma_f32_16x16x32_bf16 v[40:43], v[132:135], v[164:167], v[40:43]
    ds_read_b128 v[108:111], v214 offset:1600
    v_mfma_f32_16x16x32_bf16 v[44:47], v[132:135], v[168:171], v[44:47]
    ds_read2_b32 v[76:77], v216 offset0:16 offset1:17
    v_mfma_f32_16x16x32_bf16 v[48:51], v[132:135], v[172:175], v[48:51]
    ds_read2_b32 v[78:79], v216 offset0:18 offset1:19
    v_mfma_f32_16x16x32_bf16 v[52:55], v[132:135], v[176:179], v[52:55]
    ds_read_b128 v[112:115], v214 offset:2112
    v_mfma_f32_16x16x32_bf16 v[56:59], v[132:135], v[180:183], v[56:59]
    ds_read2_b32 v[80:81], v217 offset0:144 offset1:145
    v_mfma_f32_16x16x32_bf16 v[60:63], v[132:135], v[184:187], v[60:63]
    ds_read2_b32 v[82:83], v217 offset0:146 offset1:147
    v_mfma_f32_16x16x32_bf16 v[40:43], v[136:139], v[160:163], v[40:43]
    ds_read_b128 v[116:119], v214 offset:2624
    v_mfma_f32_16x16x32_bf16 v[44:47], v[136:139], v[164:167], v[44:47]
    ds_read2_b32 v[84:85], v217 offset0:16 offset1:17
    v_mfma_f32_16x16x32_bf16 v[48:51], v[136:139], v[168:171], v[48:51]
    ds_read2_b32 v[86:87], v217 offset0:18 offset1:19
    v_mfma_f32_16x16x32_bf16 v[52:55], v[136:139], v[172:175], v[52:55]
    ds_read_b128 v[120:123], v214 offset:3136
    v_mfma_f32_16x16x32_bf16 v[56:59], v[136:139], v[176:179], v[56:59]
    ds_read2_b32 v[88:89], v218 offset0:144 offset1:145
    v_mfma_f32_16x16x32_bf16 v[60:63], v[136:139], v[180:183], v[60:63]
    ds_read2_b32 v[90:91], v218 offset0:146 offset1:147
    v_mfma_f32_16x16x32_bf16 v[44:47], v[140:143], v[160:163], v[44:47]
    ds_read_b128 v[124:127], v214 offset:3648
    v_mfma_f32_16x16x32_bf16 v[48:51], v[140:143], v[164:167], v[48:51]
    ds_read2_b32 v[92:93], v218 offset0:16 offset1:17
    v_mfma_f32_16x16x32_bf16 v[52:55], v[140:143], v[168:171], v[52:55]
    ds_read2_b32 v[94:95], v218 offset0:18 offset1:19
    v_mfma_f32_16x16x32_bf16 v[56:59], v[140:143], v[172:175], v[56:59]
    v_mfma_f32_16x16x32_bf16 v[60:63], v[140:143], v[176:179], v[60:63]
    v_mfma_f32_16x16x32_bf16 v[48:51], v[144:147], v[160:163], v[48:51]
    v_mfma_f32_16x16x32_bf16 v[52:55], v[144:147], v[164:167], v[52:55]
    v_mfma_f32_16x16x32_bf16 v[56:59], v[144:147], v[168:171], v[56:59]
    v_mfma_f32_16x16x32_bf16 v[60:63], v[144:147], v[172:175], v[60:63]
    v_mfma_f32_16x16x32_bf16 v[52:55], v[148:151], v[160:163], v[52:55]
    v_mfma_f32_16x16x32_bf16 v[56:59], v[148:151], v[164:167], v[56:59]
    v_mfma_f32_16x16x32_bf16 v[60:63], v[148:151], v[168:171], v[60:63]
    v_mfma_f32_16x16x32_bf16 v[56:59], v[152:155], v[160:163], v[56:59]
    v_mfma_f32_16x16x32_bf16 v[60:63], v[152:155], v[164:167], v[60:63]
    v_mfma_f32_16x16x32_bf16 v[60:63], v[156:159], v[160:163], v[60:63]
    s_waitcnt lgkmcnt(0)
    v_mfma_f32_16x16x32_bf16 v[32:35], v[64:67], v[96:99], v[32:35]
    ds_read_b128 v[160:163], v214 offset:0
    v_mfma_f32_16x16x32_bf16 v[36:39], v[64:67], v[100:103], v[36:39]
    ds_read2_b32 v[128:129], v215 offset0:128 offset1:129
    v_mfma_f32_16x16x32_bf16 v[40:43], v[64:67], v[104:107], v[40:43]
    ds_read2_b32 v[130:131], v215 offset0:130 offset1:131
    v_mfma_f32_16x16x32_bf16 v[44:47], v[64:67], v[108:111], v[44:47]
    ds_read_b128 v[164:167], v214 offset:512
    v_mfma_f32_16x16x32_bf16 v[48:51], v[64:67], v[112:115], v[48:51]
    ds_read2_b32 v[132:133], v215 offset0:0 offset1:1
    v_mfma_f32_16x16x32_bf16 v[52:55], v[64:67], v[116:119], v[52:55]
    ds_read2_b32 v[134:135], v215 offset0:2 offset1:3
    v_mfma_f32_16x16x32_bf16 v[56:59], v[64:67], v[120:123], v[56:59]
    ds_read_b128 v[168:171], v214 offset:1024
    v_mfma_f32_16x16x32_bf16 v[60:63], v[64:67], v[124:127], v[60:63]
    ds_read2_b32 v[136:137], v216 offset0:128 offset1:129
    v_mfma_f32_16x16x32_bf16 v[36:39], v[68:71], v[96:99], v[36:39]
    ds_read2_b32 v[138:139], v216 offset0:130 offset1:131
    v_mfma_f32_16x16x32_bf16 v[40:43], v[68:71], v[100:103], v[40:43]
    ds_read_b128 v[172:175], v214 offset:1536
    v_mfma_f32_16x16x32_bf16 v[44:47], v[68:71], v[104:107], v[44:47]
    ds_read2_b32 v[140:141], v216 offset0:0 offset1:1
    v_mfma_f32_16x16x32_bf16 v[48:51], v[68:71], v[108:111], v[48:51]
    ds_read2_b32 v[142:143], v216 offset0:2 offset1:3
    v_mfma_f32_16x16x32_bf16 v[52:55], v[68:71], v[112:115], v[52:55]
    ds_read_b128 v[176:179], v214 offset:2048
    v_mfma_f32_16x16x32_bf16 v[56:59], v[68:71], v[116:119], v[56:59]
    ds_read2_b32 v[144:145], v217 offset0:128 offset1:129
    v_mfma_f32_16x16x32_bf16 v[60:63], v[68:71], v[120:123], v[60:63]
    ds_read2_b32 v[146:147], v217 offset0:130 offset1:131
    v_mfma_f32_16x16x32_bf16 v[40:43], v[72:75], v[96:99], v[40:43]
    ds_read_b128 v[180:183], v214 offset:2560
    v_mfma_f32_16x16x32_bf16 v[44:47], v[72:75], v[100:103], v[44:47]
    ds_read2_b32 v[148:149], v217 offset0:0 offset1:1
    v_mfma_f32_16x16x32_bf16 v[48:51], v[72:75], v[104:107], v[48:51]
    ds_read2_b32 v[150:151], v217 offset0:2 offset1:3
    v_mfma_f32_16x16x32_bf16 v[52:55], v[72:75], v[108:111], v[52:55]
    ds_read_b128 v[184:187], v214 offset:3072
    v_mfma_f32_16x16x32_bf16 v[56:59], v[72:75], v[112:115], v[56:59]
    ds_read2_b32 v[152:153], v218 offset0:128 offset1:129
    v_mfma_f32_16x16x32_bf16 v[60:63], v[72:75], v[116:119], v[60:63]
    ds_read2_b32 v[154:155], v218 offset0:130 offset1:131
    v_mfma_f32_16x16x32_bf16 v[44:47], v[76:79], v[96:99], v[44:47]
    ds_read_b128 v[188:191], v214 offset:3584
    v_mfma_f32_16x16x32_bf16 v[48:51], v[76:79], v[100:103], v[48:51]
    ds_read2_b32 v[156:157], v218 offset0:0 offset1:1
    v_mfma_f32_16x16x32_bf16 v[52:55], v[76:79], v[104:107], v[52:55]
    ds_read2_b32 v[158:159], v218 offset0:2 offset1:3
    v_mfma_f32_16x16x32_bf16 v[56:59], v[76:79], v[108:111], v[56:59]
    v_mfma_f32_16x16x32_bf16 v[60:63], v[76:79], v[112:115], v[60:63]
    v_mfma_f32_16x16x32_bf16 v[48:51], v[80:83], v[96:99], v[48:51]
    v_mfma_f32_16x16x32_bf16 v[52:55], v[80:83], v[100:103], v[52:55]
    v_mfma_f32_16x16x32_bf16 v[56:59], v[80:83], v[104:107], v[56:59]
    v_mfma_f32_16x16x32_bf16 v[60:63], v[80:83], v[108:111], v[60:63]
    v_mfma_f32_16x16x32_bf16 v[52:55], v[84:87], v[96:99], v[52:55]
    v_mfma_f32_16x16x32_bf16 v[56:59], v[84:87], v[100:103], v[56:59]
    v_mfma_f32_16x16x32_bf16 v[60:63], v[84:87], v[104:107], v[60:63]
    v_mfma_f32_16x16x32_bf16 v[56:59], v[88:91], v[96:99], v[56:59]
    v_mfma_f32_16x16x32_bf16 v[60:63], v[88:91], v[100:103], v[60:63]
    v_mfma_f32_16x16x32_bf16 v[60:63], v[92:95], v[96:99], v[60:63]
    s_waitcnt lgkmcnt(0)
    v_mfma_f32_16x16x32_bf16 v[32:35], v[128:131], v[160:163], v[32:35]
    v_mfma_f32_16x16x32_bf16 v[36:39], v[128:131], v[164:167], v[36:39]
    v_mfma_f32_16x16x32_bf16 v[40:43], v[128:131], v[168:171], v[40:43]
    v_mfma_f32_16x16x32_bf16 v[44:47], v[128:131], v[172:175], v[44:47]
    v_mfma_f32_16x16x32_bf16 v[48:51], v[128:131], v[176:179], v[48:51]
    v_mfma_f32_16x16x32_bf16 v[52:55], v[128:131], v[180:183], v[52:55]
    v_mfma_f32_16x16x32_bf16 v[56:59], v[128:131], v[184:187], v[56:59]
    v_mfma_f32_16x16x32_bf16 v[60:63], v[128:131], v[188:191], v[60:63]
    v_mfma_f32_16x16x32_bf16 v[36:39], v[132:135], v[160:163], v[36:39]
    v_mfma_f32_16x16x32_bf16 v[40:43], v[132:135], v[164:167], v[40:43]
    v_mfma_f32_16x16x32_bf16 v[44:47], v[132:135], v[168:171], v[44:47]
    v_mfma_f32_16x16x32_bf16 v[48:51], v[132:135], v[172:175], v[48:51]
    v_mfma_f32_16x16x32_bf16 v[52:55], v[132:135], v[176:179], v[52:55]
    v_mfma_f32_16x16x32_bf16 v[56:59], v[132:135], v[180:183], v[56:59]
    v_mfma_f32_16x16x32_bf16 v[60:63], v[132:135], v[184:187], v[60:63]
    v_mfma_f32_16x16x32_bf16 v[40:43], v[136:139], v[160:163], v[40:43]
    v_mfma_f32_16x16x32_bf16 v[44:47], v[136:139], v[164:167], v[44:47]
    v_mfma_f32_16x16x32_bf16 v[48:51], v[136:139], v[168:171], v[48:51]
    v_mfma_f32_16x16x32_bf16 v[52:55], v[136:139], v[172:175], v[52:55]
    v_mfma_f32_16x16x32_bf16 v[56:59], v[136:139], v[176:179], v[56:59]
    v_mfma_f32_16x16x32_bf16 v[60:63], v[136:139], v[180:183], v[60:63]
    v_mfma_f32_16x16x32_bf16 v[44:47], v[140:143], v[160:163], v[44:47]
    v_mfma_f32_16x16x32_bf16 v[48:51], v[140:143], v[164:167], v[48:51]
    v_mfma_f32_16x16x32_bf16 v[52:55], v[140:143], v[168:171], v[52:55]
    v_mfma_f32_16x16x32_bf16 v[56:59], v[140:143], v[172:175], v[56:59]
    v_mfma_f32_16x16x32_bf16 v[60:63], v[140:143], v[176:179], v[60:63]
    v_mfma_f32_16x16x32_bf16 v[48:51], v[144:147], v[160:163], v[48:51]
    v_mfma_f32_16x16x32_bf16 v[52:55], v[144:147], v[164:167], v[52:55]
    v_mfma_f32_16x16x32_bf16 v[56:59], v[144:147], v[168:171], v[56:59]
    v_mfma_f32_16x16x32_bf16 v[60:63], v[144:147], v[172:175], v[60:63]
    v_mfma_f32_16x16x32_bf16 v[52:55], v[148:151], v[160:163], v[52:55]
    v_mfma_f32_16x16x32_bf16 v[56:59], v[148:151], v[164:167], v[56:59]
    v_mfma_f32_16x16x32_bf16 v[60:63], v[148:151], v[168:171], v[60:63]
    v_mfma_f32_16x16x32_bf16 v[56:59], v[152:155], v[160:163], v[56:59]
    v_mfma_f32_16x16x32_bf16 v[60:63], v[152:155], v[164:167], v[60:63]
    v_mfma_f32_16x16x32_bf16 v[60:63], v[156:159], v[160:163], v[60:63]
    ds_write_b128 v219, v[32:35] offset:0
    ds_write_b128 v219, v[36:39] offset:1024
    ds_write_b128 v219, v[40:43] offset:2048
    ds_write_b128 v219, v[44:47] offset:3072
    ds_write_b128 v219, v[48:51] offset:4096
    ds_write_b128 v219, v[52:55] offset:5120
    ds_write_b128 v219, v[56:59] offset:6144
    s_nop 0
    ds_write_b128 v219, v[60:63] offset:7168
    s_waitcnt lgkmcnt(0)
    s_mov_b64 exec, 1
    ds_add_u32 v10, v9 offset:16
    s_mov_b64 exec, -1
L_concat_heads__ssm_conv_s4__grouped_kv_mqa__prompt_kernel_lw_11:
    ds_read_b32 v30, v10 offset:16
    s_waitcnt lgkmcnt(0)
    v_cmp_gt_u32 vcc, 8, v30
    s_cbranch_vccnz L_concat_heads__ssm_conv_s4__grouped_kv_mqa__prompt_kernel_lwr_12
    ds_read_b128 v[32:35], v220 offset:0
    ds_read_b128 v[36:39], v220 offset:256
    ds_read_b128 v[40:43], v220 offset:8192
    ds_read_b128 v[44:47], v220 offset:8448
    ds_read_b128 v[48:51], v220 offset:2048
    ds_read_b128 v[52:55], v220 offset:2304
    ds_read_b128 v[56:59], v220 offset:10240
    ds_read_b128 v[60:63], v220 offset:10496
    s_waitcnt lgkmcnt(0)
    s_mov_b64 exec, 1
    ds_add_u32 v10, v9 offset:16
    s_mov_b64 exec, -1
    v_pk_add_f32 v[32:33], v[32:33], v[40:41]
    v_pk_add_f32 v[34:35], v[34:35], v[42:43]
    v_pk_add_f32 v[36:37], v[36:37], v[44:45]
    v_pk_add_f32 v[38:39], v[38:39], v[46:47]
    v_cvt_pk_bf16_f32 v64, v32, v33
    v_cvt_pk_bf16_f32 v65, v34, v35
    v_cvt_pk_bf16_f32 v66, v36, v37
    v_cvt_pk_bf16_f32 v67, v38, v39
    global_store_dwordx4 v212, v[64:67], s[48:49] offset:0 sc1
    v_pk_add_f32 v[48:49], v[48:49], v[56:57]
    v_pk_add_f32 v[50:51], v[50:51], v[58:59]
    v_pk_add_f32 v[52:53], v[52:53], v[60:61]
    v_pk_add_f32 v[54:55], v[54:55], v[62:63]
    v_cvt_pk_bf16_f32 v68, v48, v49
    v_cvt_pk_bf16_f32 v69, v50, v51
    v_cvt_pk_bf16_f32 v70, v52, v53
    v_cvt_pk_bf16_f32 v71, v54, v55
    global_store_dwordx4 v212, v[68:71], s[48:49] offset:1024 sc1
    s_lshl_b32 s10, s7, 7
    s_lshl_b32 s11, s9, 17
    s_add_u32 s10, s10, s11
    s_lshl_b32 s11, s9, 14
    s_add_u32 s11, s11, 69632
L_concat_heads__ssm_conv_s4__grouped_kv_mqa__prompt_kernel_lw_13:
    ds_read_b32 v30, v10 offset:16
    s_waitcnt lgkmcnt(0)
    v_cmp_gt_u32 vcc, 12, v30
    s_cbranch_vccnz L_concat_heads__ssm_conv_s4__grouped_kv_mqa__prompt_kernel_lwr_14
    s_mov_b32 m0, s11
    s_add_u32 s11, s11, 4096
    buffer_load_dwordx4 v222, s[52:55], s10 offen offset:0 lds
    buffer_load_dwordx4 v223, s[52:55], s10 offen offset:1024 lds
    buffer_load_dwordx4 v224, s[52:55], s10 offen offset:2048 lds
    buffer_load_dwordx4 v225, s[52:55], s10 offen offset:3072 lds
    s_add_u32 s10, s10, 32768
    s_mov_b32 m0, s11
    s_add_u32 s11, s11, 4096
    buffer_load_dwordx4 v222, s[52:55], s10 offen offset:0 lds
    buffer_load_dwordx4 v223, s[52:55], s10 offen offset:1024 lds
    buffer_load_dwordx4 v224, s[52:55], s10 offen offset:2048 lds
    buffer_load_dwordx4 v225, s[52:55], s10 offen offset:3072 lds
    s_add_u32 s10, s10, 32768
    s_mov_b32 m0, s11
    s_add_u32 s11, s11, 4096
    buffer_load_dwordx4 v222, s[52:55], s10 offen offset:0 lds
    buffer_load_dwordx4 v223, s[52:55], s10 offen offset:1024 lds
    buffer_load_dwordx4 v224, s[52:55], s10 offen offset:2048 lds
    buffer_load_dwordx4 v225, s[52:55], s10 offen offset:3072 lds
    s_add_u32 s10, s10, 32768
    s_mov_b32 m0, s11
    s_add_u32 s11, s11, 4096
    buffer_load_dwordx4 v222, s[52:55], s10 offen offset:0 lds
    buffer_load_dwordx4 v223, s[52:55], s10 offen offset:1024 lds
    buffer_load_dwordx4 v224, s[52:55], s10 offen offset:2048 lds
    buffer_load_dwordx4 v225, s[52:55], s10 offen offset:3072 lds
    s_waitcnt vmcnt(16)
    s_mov_b64 exec, 1
    global_store_dwordx2 v221, v[244:245], s[48:49] sc1
    s_mov_b64 exec, -1
    s_mov_b32 s57, s9
    s_call_b64 s[64:65], L_red
    s_mov_b64 exec, 1
    ds_add_u32 v10, v9 offset:16
    s_mov_b64 exec, -1
L_concat_heads__ssm_conv_s4__grouped_kv_mqa__prompt_kernel_gp_15:
    global_load_dwordx2 v[26:27], v210, s[48:49] sc1
    s_waitcnt vmcnt(0)
    v_cmp_ne_u64 vcc, s[50:51], v[26:27]
    s_cbranch_vccnz L_concat_heads__ssm_conv_s4__grouped_kv_mqa__prompt_kernel_gpr_16
    global_load_dwordx4 v[40:43], v208, s[48:49] offset:-2048 sc1
    global_load_dwordx4 v[44:47], v208, s[48:49] offset:2048 sc1
    v_add_u32 v25, 8192, v209
    s_waitcnt vmcnt(0)
    v_lshlrev_b32 v12, 16, v40
    v_lshlrev_b32 v13, 16, v44
    v_lshlrev_b32 v14, 16, v200
    v_and_b32 v15, 0xffff0000, v200
    v_pk_add_f32 v[12:13], v[12:13], v[14:15]
    v_cvt_pk_bf16_f32 v48, v12, v13
    global_store_dword v209, v48, s[44:45] offset:-4096
    v_and_b32 v12, 0xffff0000, v40
    v_and_b32 v13, 0xffff0000, v44
    v_lshlrev_b32 v14, 16, v201
    v_and_b32 v15, 0xffff0000, v201
    v_pk_add_f32 v[12:13], v[12:13], v[14:15]
    v_cvt_pk_bf16_f32 v49, v12, v13
    global_store_dword v209, v49, s[44:45] offset:-2048
    v_lshlrev_b32 v12, 16, v41
    v_lshlrev_b32 v13, 16, v45
    v_lshlrev_b32 v14, 16, v202
    v_and_b32 v15, 0xffff0000, v202
    v_pk_add_f32 v[12:13], v[12:13], v[14:15]
    v_cvt_pk_bf16_f32 v50, v12, v13
    global_store_dword v209, v50, s[44:45] offset:0
    v_and_b32 v12, 0xffff0000, v41
    v_and_b32 v13, 0xffff0000, v45
    v_lshlrev_b32 v14, 16, v203
    v_and_b32 v15, 0xffff0000, v203
    v_pk_add_f32 v[12:13], v[12:13], v[14:15]
    v_cvt_pk_bf16_f32 v51, v12, v13
    global_store_dword v209, v51, s[44:45] offset:2048
    v_lshlrev_b32 v12, 16, v42
    v_lshlrev_b32 v13, 16, v46
    v_lshlrev_b32 v14, 16, v204
    v_and_b32 v15, 0xffff0000, v204
    v_pk_add_f32 v[12:13], v[12:13], v[14:15]
    v_cvt_pk_bf16_f32 v52, v12, v13
    global_store_dword v25, v52, s[44:45] offset:-4096
    v_and_b32 v12, 0xffff0000, v42
    v_and_b32 v13, 0xffff0000, v46
    v_lshlrev_b32 v14, 16, v205
    v_and_b32 v15, 0xffff0000, v205
    v_pk_add_f32 v[12:13], v[12:13], v[14:15]
    v_cvt_pk_bf16_f32 v53, v12, v13
    global_store_dword v25, v53, s[44:45] offset:-2048
    v_lshlrev_b32 v12, 16, v43
    v_lshlrev_b32 v13, 16, v47
    v_lshlrev_b32 v14, 16, v206
    v_and_b32 v15, 0xffff0000, v206
    v_pk_add_f32 v[12:13], v[12:13], v[14:15]
    v_cvt_pk_bf16_f32 v54, v12, v13
    global_store_dword v25, v54, s[44:45] offset:0
    v_and_b32 v12, 0xffff0000, v43
    v_and_b32 v13, 0xffff0000, v47
    v_lshlrev_b32 v14, 16, v207
    v_and_b32 v15, 0xffff0000, v207
    v_pk_add_f32 v[12:13], v[12:13], v[14:15]
    v_cvt_pk_bf16_f32 v55, v12, v13
    global_store_dword v25, v55, s[44:45] offset:2048
    s_cmp_lg_u32 s15, 0
    s_cbranch_scc1 L_h1
    s_add_u32 s57, s9, 4
    s_call_b64 s[64:65], L_red
L_h1:
L_concat_heads__ssm_conv_s4__grouped_kv_mqa__prompt_kernel_gp_17:
    global_load_dwordx2 v[26:27], v252, s[48:49] sc1
    s_waitcnt vmcnt(0)
    v_cmp_ne_u64 vcc, s[50:51], v[26:27]
    s_cbranch_vccnz L_concat_heads__ssm_conv_s4__grouped_kv_mqa__prompt_kernel_gpr_18
    global_load_dwordx4 v[68:71], v247, s[48:49] offset:-4096 sc1
    global_load_dwordx4 v[72:75], v247, s[48:49] offset:-3072 sc1
    global_load_dwordx4 v[76:79], v247, s[48:49] offset:-2048 sc1
    global_load_dwordx4 v[80:83], v247, s[48:49] offset:-1024 sc1
    global_load_dwordx4 v[84:87], v247, s[48:49] offset:0 sc1
    global_load_dwordx4 v[88:91], v247, s[48:49] offset:1024 sc1
    global_load_dwordx4 v[92:95], v247, s[48:49] offset:2048 sc1
    global_load_dwordx4 v[96:99], v247, s[48:49] offset:3072 sc1
    v_add_u32 v247, 8192, v247
    global_load_dwordx4 v[100:103], v247, s[48:49] offset:-4096 sc1
    global_load_dwordx4 v[104:107], v247, s[48:49] offset:-3072 sc1
    global_load_dwordx4 v[108:111], v247, s[48:49] offset:-2048 sc1
    global_load_dwordx4 v[112:115], v247, s[48:49] offset:-1024 sc1
    global_load_dwordx4 v[116:119], v247, s[48:49] offset:0 sc1
    global_load_dwordx4 v[120:123], v247, s[48:49] offset:1024 sc1
    global_load_dwordx4 v[124:127], v247, s[48:49] offset:2048 sc1
    global_load_dwordx4 v[128:131], v247, s[48:49] offset:3072 sc1
    v_add_u32 v247, 8192, v247
    global_load_dwordx4 v[132:135], v247, s[48:49] offset:-4096 sc1
    global_load_dwordx4 v[136:139], v247, s[48:49] offset:-3072 sc1
    global_load_dwordx4 v[140:143], v247, s[48:49] offset:-2048 sc1
    global_load_dwordx4 v[144:147], v247, s[48:49] offset:-1024 sc1
    global_load_dwordx4 v[148:151], v247, s[48:49] offset:0 sc1
    global_load_dwordx4 v[152:155], v247, s[48:49] offset:1024 sc1
    global_load_dwordx4 v[156:159], v247, s[48:49] offset:2048 sc1
    global_load_dwordx4 v[160:163], v247, s[48:49] offset:3072 sc1
    v_add_u32 v247, 8192, v247
    s_waitcnt vmcnt(0)
    s_cmp_lg_u32 s3, 4
    s_cbranch_scc1 L_om
    s_mov_b32 s57, 6
    s_call_b64 s[64:65], L_red
L_om:
L_concat_heads__ssm_conv_s4__grouped_kv_mqa__prompt_kernel_lw_19:
    ds_read_b32 v30, v10 offset:16
    s_waitcnt lgkmcnt(0)
    v_cmp_gt_u32 vcc, 16, v30
    s_cbranch_vccnz L_concat_heads__ssm_conv_s4__grouped_kv_mqa__prompt_kernel_lwr_20
    ds_read_b64_tr_b16 v[48:49], v246 offset:0
    ds_read_b64_tr_b16 v[50:51], v246 offset:1024
    ds_read_b64_tr_b16 v[52:53], v246 offset:8192
    ds_read_b64_tr_b16 v[54:55], v246 offset:9216
    ds_read_b64_tr_b16 v[56:57], v246 offset:16384
    ds_read_b64_tr_b16 v[58:59], v246 offset:17408
    ds_read_b64_tr_b16 v[60:61], v246 offset:24576
    ds_read_b64_tr_b16 v[62:63], v246 offset:25600
    ds_read_b64_tr_b16 v[228:229], v246 offset:32768
    ds_read_b64_tr_b16 v[230:231], v246 offset:33792
    ds_read_b64_tr_b16 v[232:233], v246 offset:40960
    ds_read_b64_tr_b16 v[234:235], v246 offset:41984
    ds_read_b64_tr_b16 v[236:237], v246 offset:49152
    ds_read_b64_tr_b16 v[238:239], v246 offset:50176
    ds_read_b64_tr_b16 v[240:241], v246 offset:57344
    ds_read_b64_tr_b16 v[242:243], v246 offset:58368
    s_cmp_lg_u32 s15, 0
    s_cbranch_scc1 L_om2
L_concat_heads__ssm_conv_s4__grouped_kv_mqa__prompt_kernel_lw_21:
    ds_read_b32 v30, v250 offset:160
    s_waitcnt lgkmcnt(0)
    v_cmp_gt_u32 vcc, 1, v30
    s_cbranch_vccnz L_concat_heads__ssm_conv_s4__grouped_kv_mqa__prompt_kernel_lwr_22
    s_call_b64 s[64:65], L_tacq
L_om2:
L_concat_heads__ssm_conv_s4__grouped_kv_mqa__prompt_kernel_lw_23:
    ds_read_b32 v30, v250 offset:176
    s_waitcnt lgkmcnt(0)
    v_cmp_gt_u32 vcc, 1, v30
    s_cbranch_vccnz L_concat_heads__ssm_conv_s4__grouped_kv_mqa__prompt_kernel_lwr_24
    v_mfma_f32_32x32x16_bf16 v[32:47], v[48:51], v[68:71], 0
    v_mfma_f32_32x32x16_bf16 v[32:47], v[52:55], v[72:75], v[32:47]
    v_mfma_f32_32x32x16_bf16 v[32:47], v[56:59], v[76:79], v[32:47]
    v_mfma_f32_32x32x16_bf16 v[32:47], v[60:63], v[80:83], v[32:47]
    ds_read_b64_tr_b16 v[48:49], v246 offset:2048
    ds_read_b64_tr_b16 v[50:51], v246 offset:3072
    ds_read_b64_tr_b16 v[52:53], v246 offset:10240
    ds_read_b64_tr_b16 v[54:55], v246 offset:11264
    ds_read_b64_tr_b16 v[56:57], v246 offset:18432
    ds_read_b64_tr_b16 v[58:59], v246 offset:19456
    ds_read_b64_tr_b16 v[60:61], v246 offset:26624
    ds_read_b64_tr_b16 v[62:63], v246 offset:27648
    s_waitcnt lgkmcnt(8)
    v_mfma_f32_32x32x16_bf16 v[32:47], v[228:231], v[84:87], v[32:47]
    v_mfma_f32_32x32x16_bf16 v[32:47], v[232:235], v[88:91], v[32:47]
    v_mfma_f32_32x32x16_bf16 v[32:47], v[236:239], v[92:95], v[32:47]
    v_mfma_f32_32x32x16_bf16 v[32:47], v[240:243], v[96:99], v[32:47]
    ds_read_b64_tr_b16 v[228:229], v246 offset:34816
    ds_read_b64_tr_b16 v[230:231], v246 offset:35840
    ds_read_b64_tr_b16 v[232:233], v246 offset:43008
    ds_read_b64_tr_b16 v[234:235], v246 offset:44032
    ds_read_b64_tr_b16 v[236:237], v246 offset:51200
    ds_read_b64_tr_b16 v[238:239], v246 offset:52224
    ds_read_b64_tr_b16 v[240:241], v246 offset:59392
    ds_read_b64_tr_b16 v[242:243], v246 offset:60416
    s_waitcnt lgkmcnt(8)
    v_mfma_f32_32x32x16_bf16 v[32:47], v[48:51], v[100:103], v[32:47]
    v_mfma_f32_32x32x16_bf16 v[32:47], v[52:55], v[104:107], v[32:47]
    v_mfma_f32_32x32x16_bf16 v[32:47], v[56:59], v[108:111], v[32:47]
    v_mfma_f32_32x32x16_bf16 v[32:47], v[60:63], v[112:115], v[32:47]
    ds_read_b64_tr_b16 v[48:49], v246 offset:4096
    ds_read_b64_tr_b16 v[50:51], v246 offset:5120
    ds_read_b64_tr_b16 v[52:53], v246 offset:12288
    ds_read_b64_tr_b16 v[54:55], v246 offset:13312
    ds_read_b64_tr_b16 v[56:57], v246 offset:20480
    ds_read_b64_tr_b16 v[58:59], v246 offset:21504
    ds_read_b64_tr_b16 v[60:61], v246 offset:28672
    ds_read_b64_tr_b16 v[62:63], v246 offset:29696
    s_waitcnt lgkmcnt(8)
    v_mfma_f32_32x32x16_bf16 v[32:47], v[228:231], v[116:119], v[32:47]
    v_mfma_f32_32x32x16_bf16 v[32:47], v[232:235], v[120:123], v[32:47]
    v_mfma_f32_32x32x16_bf16 v[32:47], v[236:239], v[124:127], v[32:47]
    v_mfma_f32_32x32x16_bf16 v[32:47], v[240:243], v[128:131], v[32:47]
    ds_read_b64_tr_b16 v[228:229], v246 offset:36864
    ds_read_b64_tr_b16 v[230:231], v246 offset:37888
    ds_read_b64_tr_b16 v[232:233], v246 offset:45056
    ds_read_b64_tr_b16 v[234:235], v246 offset:46080
    ds_read_b64_tr_b16 v[236:237], v246 offset:53248
    ds_read_b64_tr_b16 v[238:239], v246 offset:54272
    ds_read_b64_tr_b16 v[240:241], v246 offset:61440
    ds_read_b64_tr_b16 v[242:243], v246 offset:62464
    s_waitcnt lgkmcnt(8)
    v_mfma_f32_32x32x16_bf16 v[32:47], v[48:51], v[132:135], v[32:47]
    v_mfma_f32_32x32x16_bf16 v[32:47], v[52:55], v[136:139], v[32:47]
    v_mfma_f32_32x32x16_bf16 v[32:47], v[56:59], v[140:143], v[32:47]
    v_mfma_f32_32x32x16_bf16 v[32:47], v[60:63], v[144:147], v[32:47]
    ds_read_b64_tr_b16 v[48:49], v246 offset:6144
    ds_read_b64_tr_b16 v[50:51], v246 offset:7168
    ds_read_b64_tr_b16 v[52:53], v246 offset:14336
    ds_read_b64_tr_b16 v[54:55], v246 offset:15360
    ds_read_b64_tr_b16 v[56:57], v246 offset:22528
    ds_read_b64_tr_b16 v[58:59], v246 offset:23552
    ds_read_b64_tr_b16 v[60:61], v246 offset:30720
    ds_read_b64_tr_b16 v[62:63], v246 offset:31744
    s_cmp_lg_u32 s15, 0
    s_cbranch_scc0 L_om5
    s_mov_b32 s56, 0
    v_add_u32 v24, 8192, v253
    global_load_dwordx4 v[164:167], v253, s[48:49] offset:-4096 sc1
    global_load_dwordx4 v[168:171], v253, s[48:49] offset:-3072 sc1
    global_load_dwordx4 v[172:175], v253, s[48:49] offset:-2048 sc1
    global_load_dwordx4 v[176:179], v253, s[48:49] offset:-1024 sc1
    global_load_dwordx4 v[180:183], v253, s[48:49] offset:0 sc1
    global_load_dwordx4 v[184:187], v253, s[48:49] offset:1024 sc1
    global_load_dwordx4 v[188:191], v253, s[48:49] offset:2048 sc1
    global_load_dwordx4 v[192:195], v253, s[48:49] offset:3072 sc1
    global_load_dwordx4 v[196:199], v24, s[48:49] offset:-4096 sc1
    global_load_dwordx4 v[200:203], v24, s[48:49] offset:-3072 sc1
    global_load_dwordx4 v[204:207], v24, s[48:49] offset:-2048 sc1
    global_load_dwordx4 v[208:211], v24, s[48:49] offset:-1024 sc1
    global_load_dwordx4 v[212:215], v24, s[48:49] offset:0 sc1
    global_load_dwordx4 v[216:219], v24, s[48:49] offset:1024 sc1
    global_load_dwordx4 v[220:223], v24, s[48:49] offset:2048 sc1
    global_load_dwordx4 v[224:227], v24, s[48:49] offset:3072 sc1
L_om5:
    s_waitcnt lgkmcnt(8)
    v_mfma_f32_32x32x16_bf16 v[32:47], v[228:231], v[148:151], v[32:47]
    v_mfma_f32_32x32x16_bf16 v[32:47], v[232:235], v[152:155], v[32:47]
    v_mfma_f32_32x32x16_bf16 v[32:47], v[236:239], v[156:159], v[32:47]
    v_mfma_f32_32x32x16_bf16 v[32:47], v[240:243], v[160:163], v[32:47]
    ds_read_b64_tr_b16 v[228:229], v246 offset:38912
    ds_read_b64_tr_b16 v[230:231], v246 offset:39936
    ds_read_b64_tr_b16 v[232:233], v246 offset:47104
    ds_read_b64_tr_b16 v[234:235], v246 offset:48128
    ds_read_b64_tr_b16 v[236:237], v246 offset:55296
    ds_read_b64_tr_b16 v[238:239], v246 offset:56320
    ds_read_b64_tr_b16 v[240:241], v246 offset:63488
    ds_read_b64_tr_b16 v[242:243], v246 offset:64512
    s_cmp_lg_u32 s15, 0
    s_cbranch_scc1 L_om4
    s_waitcnt lgkmcnt(0)
    v_mfma_f32_32x32x16_bf16 v[32:47], v[48:51], v[166:169], v[32:47]
    v_mfma_f32_32x32x16_bf16 v[32:47], v[52:55], v[174:177], v[32:47]
    v_mfma_f32_32x32x16_bf16 v[32:47], v[56:59], v[182:185], v[32:47]
    v_mfma_f32_32x32x16_bf16 v[32:47], v[60:63], v[190:193], v[32:47]
    v_mfma_f32_32x32x16_bf16 v[32:47], v[228:231], v[198:201], v[32:47]
    v_mfma_f32_32x32x16_bf16 v[32:47], v[232:235], v[206:209], v[32:47]
    v_mfma_f32_32x32x16_bf16 v[32:47], v[236:239], v[214:217], v[32:47]
    v_mfma_f32_32x32x16_bf16 v[32:47], v[240:243], v[222:225], v[32:47]
    s_branch L_opfin
L_om4:
    s_waitcnt lgkmcnt(0)
L_tc0:
    s_waitcnt vmcnt(14)
    v_cmp_ne_u64 vcc, s[50:51], v[164:165]
    v_cmp_ne_u64 s[12:13], s[50:51], v[170:171]
    s_nop 0
    s_or_b64 vcc, vcc, s[12:13]
    s_cbranch_scc1 L_tr0
    v_mfma_f32_32x32x16_bf16 v[32:47], v[48:51], v[166:169], v[32:47]
L_tc1:
    s_waitcnt vmcnt(12)
    v_cmp_ne_u64 vcc, s[50:51], v[172:173]
    v_cmp_ne_u64 s[12:13], s[50:51], v[178:179]
    s_nop 0
    s_or_b64 vcc, vcc, s[12:13]
    s_cbranch_scc1 L_tr1
    v_mfma_f32_32x32x16_bf16 v[32:47], v[52:55], v[174:177], v[32:47]
L_tc2:
    s_waitcnt vmcnt(10)
    v_cmp_ne_u64 vcc, s[50:51], v[180:181]
    v_cmp_ne_u64 s[12:13], s[50:51], v[186:187]
    s_nop 0
    s_or_b64 vcc, vcc, s[12:13]
    s_cbranch_scc1 L_tr2
    v_mfma_f32_32x32x16_bf16 v[32:47], v[56:59], v[182:185], v[32:47]
L_tc3:
    s_waitcnt vmcnt(8)
    v_cmp_ne_u64 vcc, s[50:51], v[188:189]
    v_cmp_ne_u64 s[12:13], s[50:51], v[194:195]
    s_nop 0
    s_or_b64 vcc, vcc, s[12:13]
    s_cbranch_scc1 L_tr3
    v_mfma_f32_32x32x16_bf16 v[32:47], v[60:63], v[190:193], v[32:47]
L_tc4:
    s_waitcnt vmcnt(6)
    v_cmp_ne_u64 vcc, s[50:51], v[196:197]
    v_cmp_ne_u64 s[12:13], s[50:51], v[202:203]
    s_nop 0
    s_or_b64 vcc, vcc, s[12:13]
    s_cbranch_scc1 L_tr4
    v_mfma_f32_32x32x16_bf16 v[32:47], v[228:231], v[198:201], v[32:47]
L_tc5:
    s_waitcnt vmcnt(4)
    v_cmp_ne_u64 vcc, s[50:51], v[204:205]
    v_cmp_ne_u64 s[12:13], s[50:51], v[210:211]
    s_nop 0
    s_or_b64 vcc, vcc, s[12:13]
    s_cbranch_scc1 L_tr5
    v_mfma_f32_32x32x16_bf16 v[32:47], v[232:235], v[206:209], v[32:47]
L_tc6:
    s_waitcnt vmcnt(2)
    v_cmp_ne_u64 vcc, s[50:51], v[212:213]
    v_cmp_ne_u64 s[12:13], s[50:51], v[218:219]
    s_nop 0
    s_or_b64 vcc, vcc, s[12:13]
    s_cbranch_scc1 L_tr6
    v_mfma_f32_32x32x16_bf16 v[32:47], v[236:239], v[214:217], v[32:47]
L_tc7:
    s_waitcnt vmcnt(0)
    v_cmp_ne_u64 vcc, s[50:51], v[220:221]
    v_cmp_ne_u64 s[12:13], s[50:51], v[226:227]
    s_nop 0
    s_or_b64 vcc, vcc, s[12:13]
    s_cbranch_scc1 L_tr7
    v_mfma_f32_32x32x16_bf16 v[32:47], v[240:243], v[222:225], v[32:47]
L_opfin:
    s_nop 11
    v_cvt_pk_bf16_f32 v16, v32, v33
    v_cvt_pk_bf16_f32 v17, v34, v35
    v_cvt_pk_bf16_f32 v18, v36, v37
    v_cvt_pk_bf16_f32 v19, v38, v39
    v_cvt_pk_bf16_f32 v20, v40, v41
    v_cvt_pk_bf16_f32 v21, v42, v43
    v_cvt_pk_bf16_f32 v22, v44, v45
    v_cvt_pk_bf16_f32 v23, v46, v47
    v_permlane32_swap_b32 v16, v18
    v_permlane32_swap_b32 v17, v19
    v_permlane32_swap_b32 v20, v22
    v_permlane32_swap_b32 v21, v23
    global_store_dwordx4 v248, v[16:19], s[44:45] offset:1024
    global_store_dwordx4 v248, v[20:23], s[44:45] offset:1056
    s_branch L_end
L_tacq:
    s_mov_b32 s56, 0
L_tpre:
    v_add_u32 v24, 8192, v253
    global_load_dwordx2 v[26:27], v255, s[48:49] sc1
    s_waitcnt vmcnt(0)
    v_cmp_ne_u64 vcc, s[50:51], v[26:27]
    s_cbranch_vccnz L_tprer
    global_load_dwordx4 v[164:167], v253, s[48:49] offset:-4096 sc1
    global_load_dwordx4 v[168:171], v253, s[48:49] offset:-3072 sc1
    global_load_dwordx4 v[172:175], v253, s[48:49] offset:-2048 sc1
    global_load_dwordx4 v[176:179], v253, s[48:49] offset:-1024 sc1
    global_load_dwordx4 v[180:183], v253, s[48:49] offset:0 sc1
    global_load_dwordx4 v[184:187], v253, s[48:49] offset:1024 sc1
    global_load_dwordx4 v[188:191], v253, s[48:49] offset:2048 sc1
    global_load_dwordx4 v[192:195], v253, s[48:49] offset:3072 sc1
    global_load_dwordx4 v[196:199], v24, s[48:49] offset:-4096 sc1
    global_load_dwordx4 v[200:203], v24, s[48:49] offset:-3072 sc1
    global_load_dwordx4 v[204:207], v24, s[48:49] offset:-2048 sc1
    global_load_dwordx4 v[208:211], v24, s[48:49] offset:-1024 sc1
    global_load_dwordx4 v[212:215], v24, s[48:49] offset:0 sc1
    global_load_dwordx4 v[216:219], v24, s[48:49] offset:1024 sc1
    global_load_dwordx4 v[220:223], v24, s[48:49] offset:2048 sc1
    global_load_dwordx4 v[224:227], v24, s[48:49] offset:3072 sc1
    s_mov_b64 s[10:11], 0
    s_waitcnt vmcnt(14)
    v_cmp_ne_u64 vcc, s[50:51], v[164:165]
    v_cmp_ne_u64 s[12:13], s[50:51], v[170:171]
    s_or_b64 s[10:11], s[10:11], vcc
    s_or_b64 s[10:11], s[10:11], s[12:13]
    s_waitcnt vmcnt(12)
    v_cmp_ne_u64 vcc, s[50:51], v[172:173]
    v_cmp_ne_u64 s[12:13], s[50:51], v[178:179]
    s_or_b64 s[10:11], s[10:11], vcc
    s_or_b64 s[10:11], s[10:11], s[12:13]
    s_waitcnt vmcnt(10)
    v_cmp_ne_u64 vcc, s[50:51], v[180:181]
    v_cmp_ne_u64 s[12:13], s[50:51], v[186:187]
    s_or_b64 s[10:11], s[10:11], vcc
    s_or_b64 s[10:11], s[10:11], s[12:13]
    s_waitcnt vmcnt(8)
    v_cmp_ne_u64 vcc, s[50:51], v[188:189]
    v_cmp_ne_u64 s[12:13], s[50:51], v[194:195]
    s_or_b64 s[10:11], s[10:11], vcc
    s_or_b64 s[10:11], s[10:11], s[12:13]
    s_waitcnt vmcnt(6)
    v_cmp_ne_u64 vcc, s[50:51], v[196:197]
    v_cmp_ne_u64 s[12:13], s[50:51], v[202:203]
    s_or_b64 s[10:11], s[10:11], vcc
    s_or_b64 s[10:11], s[10:11], s[12:13]
    s_waitcnt vmcnt(4)
    v_cmp_ne_u64 vcc, s[50:51], v[204:205]
    v_cmp_ne_u64 s[12:13], s[50:51], v[210:211]
    s_or_b64 s[10:11], s[10:11], vcc
    s_or_b64 s[10:11], s[10:11], s[12:13]
    s_waitcnt vmcnt(2)
    v_cmp_ne_u64 vcc, s[50:51], v[212:213]
    v_cmp_ne_u64 s[12:13], s[50:51], v[218:219]
    s_or_b64 s[10:11], s[10:11], vcc
    s_or_b64 s[10:11], s[10:11], s[12:13]
    s_waitcnt vmcnt(0)
    v_cmp_ne_u64 vcc, s[50:51], v[220:221]
    v_cmp_ne_u64 s[12:13], s[50:51], v[226:227]
    s_or_b64 s[10:11], s[10:11], vcc
    s_or_b64 s[10:11], s[10:11], s[12:13]
    s_cbranch_scc1 L_tprer
    s_setpc_b64 s[64:65]
L_red:
    s_lshl_b32 s10, s57, 4
    v_add_u32 v24, s10, v250
    s_mul_i32 s10, s57, 8704
    v_add_u32 v25, s10, v6
    v_add_u32 v26, s10, v249
    s_lshl_b32 s11, s57, 2
    s_lshr_b32 s11, 0x73654210, s11
    s_and_b32 s11, s11, 15
    s_lshl_b32 s10, s11, 13
    v_add_u32 v27, s10, v251
    s_lshl_b32 s10, s11, 10
    s_add_u32 s10, s10, s58
    v_mov_b32 v28, s10
L_concat_heads__ssm_conv_s4__grouped_kv_mqa__prompt_kernel_lw_25:
    ds_read_b32 v30, v24 offset:64
    s_waitcnt lgkmcnt(0)
    v_cmp_gt_u32 vcc, 1, v30
    s_cbranch_vccnz L_concat_heads__ssm_conv_s4__grouped_kv_mqa__prompt_kernel_lwr_26
L_red2:
    ds_read_b128 v[32:35], v25 offset:0
    ds_read_b128 v[36:39], v25 offset:1024
    ds_read_b32 v64, v26 offset:2048
    ds_read_b128 v[40:43], v25 offset:2176
    ds_read_b128 v[44:47], v25 offset:3200
    ds_read_b32 v65, v26 offset:4224
    ds_read_b128 v[48:51], v25 offset:4352
    ds_read_b128 v[52:55], v25 offset:5376
    ds_read_b32 v66, v26 offset:6400
    ds_read_b128 v[56:59], v25 offset:6528
    ds_read_b128 v[60:63], v25 offset:7552
    ds_read_b32 v67, v26 offset:8576
    s_mov_b32 s10, 0x21800000
    s_mov_b32 s11, 0x3c000000
    s_waitcnt lgkmcnt(6)
    v_pk_add_f32 v[32:33], v[32:33], v[40:41]
    v_pk_add_f32 v[34:35], v[34:35], v[42:43]
    v_pk_add_f32 v[36:37], v[36:37], v[44:45]
    v_pk_add_f32 v[38:39], v[38:39], v[46:47]
    s_waitcnt lgkmcnt(0)
    v_pk_add_f32 v[64:65], v[64:65], v[66:67]
    v_pk_add_f32 v[48:49], v[48:49], v[56:57]
    v_pk_add_f32 v[50:51], v[50:51], v[58:59]
    v_pk_add_f32 v[52:53], v[52:53], v[60:61]
    v_pk_add_f32 v[54:55], v[54:55], v[62:63]
    v_add_f32 v64, v64, v65
    v_pk_add_f32 v[32:33], v[32:33], v[48:49]
    v_pk_add_f32 v[34:35], v[34:35], v[50:51]
    v_pk_add_f32 v[36:37], v[36:37], v[52:53]
    v_pk_add_f32 v[38:39], v[38:39], v[54:55]
    v_subrev_u32 v65, s10, v64
    v_cmp_lt_u32 vcc, s11, v65
    s_cbranch_vccnz L_fallback
L_rednorm:
    v_rcp_f32 v64, v64
    s_cmp_ge_u32 s57, 6
    v_pk_mul_f32 v[32:33], v[32:33], v[64:65] op_sel_hi:[1,0]
    v_pk_mul_f32 v[34:35], v[34:35], v[64:65] op_sel_hi:[1,0]
    v_pk_mul_f32 v[36:37], v[36:37], v[64:65] op_sel_hi:[1,0]
    v_pk_mul_f32 v[38:39], v[38:39], v[64:65] op_sel_hi:[1,0]
    v_cvt_pk_bf16_f32 v18, v32, v33
    v_cvt_pk_bf16_f32 v19, v34, v35
    v_cvt_pk_bf16_f32 v20, v36, v37
    v_cvt_pk_bf16_f32 v21, v38, v39
    s_cbranch_scc0 L_redplain
    v_mov_b64 v[16:17], v[244:245]
    v_mov_b64 v[22:23], v[244:245]
    global_store_dwordx4 v254, v[16:19], s[48:49]
    global_store_dwordx4 v254, v[20:23], s[48:49] offset:1024
    v_xor_b32 v24, 1048576, v254
    global_store_dwordx4 v24, v[16:19], s[48:49] sc1
    global_store_dwordx4 v24, v[20:23], s[48:49] offset:1024 sc1
    s_setpc_b64 s[64:65]
L_redplain:
    global_store_dwordx4 v27, v[18:21], s[48:49] sc1
    s_waitcnt vmcnt(0)
    s_mov_b64 exec, 1
    global_store_dwordx2 v28, v[244:245], s[48:49] sc1
    s_mov_b64 exec, -1
    s_setpc_b64 s[64:65]
L_fallback:
    s_lshl_b32 s10, s57, 10
    s_add_u32 s10, s10, 147712
    v_add_u32 v11, s10, v6
    ds_read_b128 v[64:67], v11
    v_mov_b32 v11, v6
    v_mov_b32 v29, 0xff800000
    s_mov_b32 s10, 64
L_fb1:
    global_load_dwordx4 v[12:15], v11, s[48:49] sc1
    v_add_u32 v11, 1024, v11
    s_waitcnt vmcnt(0) lgkmcnt(0)
    v_mfma_f32_32x32x16_bf16 v[48:63], v[12:15], v[64:67], 0
    s_sub_u32 s10, s10, 1
    s_cmp_lg_u32 s10, 0
    s_nop 9
    v_max3_f32 v29, v48, v49, v29
    v_max3_f32 v29, v50, v51, v29
    v_max3_f32 v29, v52, v53, v29
    v_max3_f32 v29, v54, v55, v29
    v_max3_f32 v29, v56, v57, v29
    v_max3_f32 v29, v58, v59, v29
    v_max3_f32 v29, v60, v61, v29
    v_max3_f32 v29, v62, v63, v29
    s_cbranch_scc1 L_fb1
    v_mov_b32 v30, v29
    s_nop 1
    v_permlane32_swap_b32 v29, v30
    v_max_f32 v29, v29, v30
    v_mov_b32 v32, 0
    v_mov_b32 v33, 0
    v_mov_b32 v34, 0
    v_mov_b32 v35, 0
    v_mov_b32 v36, 0
    v_mov_b32 v37, 0
    v_mov_b32 v38, 0
    v_mov_b32 v39, 0
    v_mov_b32 v40, 0
    v_mov_b32 v41, 0
    v_mov_b32 v42, 0
    v_mov_b32 v43, 0
    v_mov_b32 v44, 0
    v_mov_b32 v45, 0
    v_mov_b32 v46, 0
    v_mov_b32 v47, 0
    v_mov_b32 v16, 0x3f803f80
    v_mov_b32 v17, 0x3f803f80
    v_mov_b32 v18, 0x3f803f80
    v_mov_b32 v19, 0x3f803f80
    v_mov_b32 v20, 0x3f803f80
    v_mov_b32 v21, 0x3f803f80
    v_mov_b32 v22, 0x3f803f80
    v_mov_b32 v23, 0x3f803f80
    v_mov_b32 v30, 0xdddddddd
    v_mov_b32 v11, v6
    v_lshlrev_b32 v31, 9, v5
    v_lshl_add_u32 v31, v3, 4, v31
    v_add_u32 v31, 65536, v31
    s_mov_b32 s10, 64
L_fb2:
    global_load_dwordx4 v[12:15], v11, s[48:49] sc1
    s_mov_b32 exec_lo, 0xffff
    s_mov_b32 exec_hi, 0xffff
    global_load_dwordx4 v[16:19], v31, s[48:49] sc1
    global_load_dwordx4 v[20:23], v31, s[48:49] offset:256 sc1
    s_mov_b64 exec, -1
    v_add_u32 v11, 1024, v11
    v_add_u32 v31, 1024, v31
    s_waitcnt vmcnt(0)
    v_mfma_f32_32x32x16_bf16 v[48:63], v[12:15], v[64:67], 0
    s_sub_u32 s10, s10, 1
    s_cmp_lg_u32 s10, 0
    s_nop 9
    v_sub_f32 v48, v48, v29
    v_sub_f32 v49, v49, v29
    v_sub_f32 v50, v50, v29
    v_sub_f32 v51, v51, v29
    v_sub_f32 v52, v52, v29
    v_sub_f32 v53, v53, v29
    v_sub_f32 v54, v54, v29
    v_sub_f32 v55, v55, v29
    v_sub_f32 v56, v56, v29
    v_sub_f32 v57, v57, v29
    v_sub_f32 v58, v58, v29
    v_sub_f32 v59, v59, v29
    v_sub_f32 v60, v60, v29
    v_sub_f32 v61, v61, v29
    v_sub_f32 v62, v62, v29
    v_sub_f32 v63, v63, v29
    v_exp_f32 v48, v48
    v_exp_f32 v49, v49
    v_exp_f32 v50, v50
    v_exp_f32 v51, v51
    v_exp_f32 v52, v52
    v_exp_f32 v53, v53
    v_exp_f32 v54, v54
    v_exp_f32 v55, v55
    v_exp_f32 v56, v56
    v_exp_f32 v57, v57
    v_exp_f32 v58, v58
    v_exp_f32 v59, v59
    v_exp_f32 v60, v60
    v_exp_f32 v61, v61
    v_exp_f32 v62, v62
    v_exp_f32 v63, v63
    v_smfmac_f32_32x32x32_bf16 v[32:47], v[16:19], v[48:55], v30
    s_nop 0
    v_smfmac_f32_32x32x32_bf16 v[32:47], v[20:23], v[56:63], v30
    s_nop 7
    s_nop 7
    s_cbranch_scc1 L_fb2
    v_mov_b32 v64, v40
    s_branch L_rednorm
L_setup:
    s_and_b32 s9, s3, 3
    s_and_b32 s14, s3, 1
    s_bfe_u32 s15, s3, 0x10001
    v_and_b32 v13, 7, v1
    s_lshl_b32 s10, s4, 7
    s_lshl_b32 s11, s9, 5
    s_add_u32 s10, s10, s11
    v_lshl_add_u32 v228, v13, 2, s10
    v_and_b32 v12, 56, v1
    s_lshl_b32 s10, s5, 6
    v_add_u32 v12, s10, v12
    v_lshl_add_u32 v227, v12, 10, v228
    v_add_u32 v227, 4096, v227
    v_lshlrev_b32 v208, 11, v228
    v_lshl_add_u32 v208, v12, 1, v208
    v_add_u32 v208, 2885632, v208
    v_lshl_add_u32 v209, v12, 11, v228
    v_add_u32 v209, 4096, v209
    s_lshl2_add_u32 s10, s4, s9
    s_lshl_b32 s10, s10, 5
    s_add_u32 s10, s10, s5
    s_lshl_b32 s10, s10, 7
    s_add_u32 s10, s10, 2621440
    v_mov_b32 v226, s10
    s_lshr_b32 s10, s5, 3
    s_lshl2_add_u32 s10, s4, s10
    s_lshl1_add_u32 s10, s10, s15
    s_lshl_b32 s10, s10, 11
    s_add_u32 s10, s10, 2621440
    v_lshl_add_u32 v211, v3, 7, s10
    s_lshl1_add_u32 s10, s8, s14
    s_lshl1_add_u32 s10, s10, s15
    s_lshl_b32 s10, s10, 11
    s_add_u32 s10, s10, 2883584
    v_add_u32 v212, s10, v6
    s_mul_i32 s57, s14, 4576
    s_lshl_b32 s11, s15, 11
    s_add_u32 s10, s57, s11
    s_add_u32 s10, s10, 70112
    v_add_u32 v213, s10, v6
    s_mul_i32 s56, s14, 8320
    v_add_u32 v11, 1, v3
    v_and_b32 v11, 30, v11
    v_lshlrev_b32 v11, 1, v11
    v_lshlrev_b32 v12, 4, v4
    v_sub_u32 v11, v12, v11
    v_and_b32 v12, 1, v3
    v_mul_u32_u24 v12, 4160, v12
    s_lshl_b32 s11, s15, 8
    s_sub_u32 s10, s56, s11
    s_add_u32 s10, s10, 134432
    v_add3_u32 v215, v11, v12, s10
    v_subrev_u32 v216, 1024, v215
    v_subrev_u32 v217, 2048, v215
    v_subrev_u32 v218, 3072, v215
    v_lshlrev_b32 v11, 5, v3
    v_lshl_add_u32 v11, v4, 4, v11
    s_sub_u32 s10, s57, s11
    s_add_u32 s10, s10, 69888
    v_add_u32 v214, s10, v11
    s_lshl1_add_u32 s10, s14, s15
    s_lshl_b32 s10, s10, 13
    s_add_u32 s10, s10, 78848
    v_add_u32 v219, s10, v6
    v_bfe_u32 v12, v1, 1, 4
    v_and_b32 v11, 1, v1
    v_lshl_add_u32 v12, v11, 5, v12
    v_lshlrev_b32 v12, 4, v12
    v_lshl_add_u32 v12, v5, 10, v12
    s_lshl_b32 s10, s14, 14
    s_lshl_b32 s11, s15, 12
    s_add_u32 s10, s10, s11
    s_add_u32 s10, s10, 78848
    v_add_u32 v220, s10, v12
    s_lshl1_add_u32 s10, s4, s15
    s_lshl_b32 s10, s10, 5
    s_add_u32 s10, s10, s5
    s_lshl1_add_u32 s10, s10, s14
    s_lshl_b32 s10, s10, 7
    s_add_u32 s10, s10, 2752512
    v_mov_b32 v221, s10
    s_lshr_b32 s10, s5, 4
    s_lshl1_add_u32 s10, s4, s10
    s_lshl2_add_u32 s10, s10, s9
    s_lshl_b32 s10, s10, 11
    s_add_u32 s10, s10, 2752512
    v_lshl_add_u32 v210, v3, 7, s10
    v_lshrrev_b32 v11, 3, v1
    v_and_b32 v12, 1, v4
    v_lshlrev_b32 v12, 2, v12
    v_xor_b32 v12, v12, v13
    v_lshlrev_b32 v12, 4, v12
    v_lshl_add_u32 v222, v11, 10, v12
    v_add_u32 v223, 7168, v222
    v_add_u32 v224, 14336, v222
    v_add_u32 v225, 21504, v222
    v_lshrrev_b32 v11, 2, v3
    v_lshl_add_u32 v11, v5, 2, v11
    v_lshlrev_b32 v11, 7, v11
    v_lshrrev_b32 v12, 3, v3
    v_xor_b32 v12, s14, v12
    v_lshl_add_u32 v11, v12, 6, v11
    v_and_b32 v12, 1, v4
    v_lshl_add_u32 v11, v12, 5, v11
    v_and_b32 v12, 3, v1
    v_lshl_add_u32 v11, v12, 3, v11
    v_add_u32 v246, 69632, v11
    s_lshl1_add_u32 s10, s6, s15
    s_lshl_b32 s11, s10, 15
    s_add_u32 s11, s11, 266240
    v_add_u32 v247, s11, v6
    s_lshl_b32 s11, s10, 12
    s_add_u32 s11, s11, 2359296
    v_min_u32 v11, 23, v1
    v_lshl_add_u32 v252, v11, 7, s11
    v_lshl_add_u32 v250, v12, 2, v10
    v_and_b32 v11, 31, v1
    v_lshlrev_b32 v12, 11, v11
    v_lshl_add_u32 v12, v5, 4, v12
    s_lshl_b32 s10, s10, 16
    s_lshl_b32 s11, s7, 7
    s_add_u32 s10, s10, s11
    s_lshl_b32 s11, s14, 6
    s_add_u32 s10, s10, s11
    v_add_u32 v248, s10, v12
    v_lshlrev_b32 v249, 2, v11
    s_lshl_b32 s10, s6, 6
    s_add_u32 s10, s10, s7
    s_lshl_b32 s11, s10, 10
    s_add_u32 s11, s11, 262144
    v_add_u32 v251, s11, v6
    s_lshl_b32 s10, s10, 7
    s_add_u32 s58, s10, 2359296
    s_lshl1_add_u32 s10, s6, s15
    s_lshl_b32 s10, s10, 14
    s_add_u32 s10, s10, 10489856
    v_add_u32 v253, s10, v6
    s_add_u32 s10, s10, -2056
    v_lshl_add_u32 v255, v13, 11, s10
    s_lshl_b32 s10, s6, 15
    s_lshl_b32 s11, s7, 11
    s_add_u32 s10, s10, s11
    s_add_u32 s10, s10, 10485760
    v_add_u32 v254, s10, v6
    s_setpc_b64 s[64:65]
L_attn:
    s_setprio 2
    s_mov_b32 vcc_lo, 0x00110011
    s_mov_b32 vcc_hi, 0x00110011
    v_mov_b32 v12, 0x3f803f80
    v_cndmask_b32 v12, 0, v12, vcc
    v_mov_b32 v13, v12
    v_mov_b64 v[132:133], v[12:13]
    v_mov_b64 v[134:135], v[12:13]
    v_mov_b64 v[140:141], v[12:13]
    v_mov_b64 v[142:143], v[12:13]
    v_mov_b64 v[148:149], v[12:13]
    v_mov_b64 v[150:151], v[12:13]
    v_mov_b64 v[156:157], v[12:13]
    v_mov_b64 v[158:159], v[12:13]
    v_mov_b64 v[164:165], v[12:13]
    v_mov_b64 v[166:167], v[12:13]
    v_mov_b64 v[172:173], v[12:13]
    v_mov_b64 v[174:175], v[12:13]
    v_mov_b64 v[180:181], v[12:13]
    v_mov_b64 v[182:183], v[12:13]
    v_mov_b64 v[188:189], v[12:13]
    v_mov_b64 v[190:191], v[12:13]
    v_mov_b64 v[196:197], v[12:13]
    v_mov_b64 v[198:199], v[12:13]
    v_mov_b64 v[204:205], v[12:13]
    v_mov_b64 v[206:207], v[12:13]
    v_mov_b64 v[212:213], v[12:13]
    v_mov_b64 v[214:215], v[12:13]
    v_mov_b64 v[220:221], v[12:13]
    v_mov_b64 v[222:223], v[12:13]
    v_mov_b64 v[228:229], v[12:13]
    v_mov_b64 v[230:231], v[12:13]
    v_mov_b64 v[236:237], v[12:13]
    v_mov_b64 v[238:239], v[12:13]
    v_mov_b64 v[244:245], v[12:13]
    v_mov_b64 v[246:247], v[12:13]
    v_mov_b64 v[252:253], v[12:13]
    v_mov_b64 v[254:255], v[12:13]
    s_and_b32 s9, s3, 1
    s_lshr_b32 s10, s3, 1
    v_and_b32 v11, 31, v1
    s_lshl_b32 s11, s9, 5
    v_add_u32 v11, s11, v11
    v_xor_b32 v12, v5, v3
    v_lshlrev_b32 v12, 4, v12
    v_lshl_add_u32 v32, v11, 8, v12
    v_xor_b32 v33, 32, v32
    v_xor_b32 v34, 64, v32
    v_xor_b32 v35, 96, v32
    v_xor_b32 v36, 128, v32
    v_xor_b32 v37, 160, v32
    v_xor_b32 v38, 192, v32
    v_xor_b32 v39, 224, v32
    v_lshrrev_b32 v40, 2, v3
    v_lshl_add_u32 v40, v5, 3, v40
    v_lshlrev_b32 v40, 7, v40
    v_lshrrev_b32 v41, 3, v3
    v_xor_b32 v41, s10, v41
    v_lshl_add_u32 v40, v41, 6, v40
    v_and_b32 v41, 1, v4
    v_lshl_add_u32 v40, v41, 5, v40
    v_and_b32 v41, 3, v1
    v_lshl_add_u32 v40, v41, 3, v40
    v_add_u32 v40, 16384, v40
    s_lshl1_add_u32 s11, s9, s10
    s_lshl_b32 s11, s11, 3
    s_lshr_b32 s11, 0x75436210, s11
    s_and_b32 s12, s11, 15
    s_lshl_b32 s12, s12, 10
    s_add_u32 s12, s12, 147712
    v_add_u32 v48, s12, v6
    s_bfe_u32 s12, s11, 0x40004
    s_lshl_b32 s12, s12, 10
    s_add_u32 s12, s12, 147712
    v_add_u32 v50, s12, v6
    s_lshl_b32 s11, s3, 14
    s_add_u32 s11, s11, 4096
    v_add_u32 v0, s11, v6
    v_add_u32 v3, 65536, v0
    v_add_u32 v4, 8192, v0
    v_add_u32 v5, 8192, v3
    v_add_u32 v7, 147712, v6
    s_mul_i32 s11, s3, 2176
    v_add_u32 v8, s11, v6
    v_and_b32 v2, 31, v1
    v_lshl_add_u32 v2, v2, 2, s11
    s_lshl_b32 s11, s3, 2
    s_lshl_b32 s12, s3, 9
    s_add_u32 s12, s12, 163840
    v_lshl_add_u32 v49, v1, 3, s12
    v_add_u32 v1, s11, v10
    v_mov_b32 v11, 0xdddddddd
L_concat_heads__ssm_conv_s4__grouped_kv_mqa__prompt_kernel_lw_27:
    ds_read_b32 v44, v10 offset:0
    s_waitcnt lgkmcnt(0)
    v_cmp_gt_u32 vcc, 1, v44
    s_cbranch_vccnz L_concat_heads__ssm_conv_s4__grouped_kv_mqa__prompt_kernel_lwr_28
    s_mul_i32 s50, s50, 0x9e3779b1
    s_add_u32 s50, s50, 0x7f4a7c15
    s_xor_b32 s51, s51, s50
    s_mul_i32 s51, s51, 0x85ebca6b
    s_add_u32 s51, s51, 0x2545f491
    ds_read_b128 v[88:91], v32 offset:0
    ds_read_b64_tr_b16 v[92:93], v40 offset:0
    ds_read_b64_tr_b16 v[94:95], v40 offset:512
    ds_read_b128 v[96:99], v33 offset:0
    ds_read_b64_tr_b16 v[100:101], v40 offset:2048
    ds_read_b64_tr_b16 v[102:103], v40 offset:2560
    ds_read_b128 v[104:107], v34 offset:0
    ds_read_b64_tr_b16 v[108:109], v40 offset:4096
    ds_read_b64_tr_b16 v[110:111], v40 offset:4608
    ds_read_b128 v[112:115], v35 offset:0
    ds_read_b64_tr_b16 v[116:117], v40 offset:6144
    ds_read_b64_tr_b16 v[118:119], v40 offset:6656
    s_waitcnt lgkmcnt(9)
    v_mfma_f32_32x32x16_bf16 v[16:31], v[92:95], v[88:91], 0
    ds_read_b128 v[120:123], v36 offset:0
    ds_read_b64_tr_b16 v[124:125], v40 offset:8192
    ds_read_b64_tr_b16 v[126:127], v40 offset:8704
    s_waitcnt lgkmcnt(9)
    v_mfma_f32_32x32x16_bf16 v[16:31], v[100:103], v[96:99], v[16:31]
    ds_read_b128 v[248:251], v37 offset:0
    ds_read_b64_tr_b16 v[240:241], v40 offset:10240
    ds_read_b64_tr_b16 v[242:243], v40 offset:10752
    s_waitcnt lgkmcnt(9)
    v_mfma_f32_32x32x16_bf16 v[16:31], v[108:111], v[104:107], v[16:31]
    ds_read_b128 v[232:235], v38 offset:0
    ds_read_b64_tr_b16 v[224:225], v40 offset:12288
    ds_read_b64_tr_b16 v[226:227], v40 offset:12800
    s_waitcnt lgkmcnt(9)
    v_mfma_f32_32x32x16_bf16 v[16:31], v[116:119], v[112:115], v[16:31]
    ds_read_b128 v[216:219], v39 offset:0
    ds_read_b64_tr_b16 v[208:209], v40 offset:14336
    ds_read_b64_tr_b16 v[210:211], v40 offset:14848
    s_waitcnt lgkmcnt(9)
    v_mfma_f32_32x32x16_bf16 v[16:31], v[124:127], v[120:123], v[16:31]
    s_waitcnt lgkmcnt(6)
    v_mfma_f32_32x32x16_bf16 v[16:31], v[240:243], v[248:251], v[16:31]
    s_waitcnt lgkmcnt(3)
    v_mfma_f32_32x32x16_bf16 v[16:31], v[224:227], v[232:235], v[16:31]
    s_waitcnt lgkmcnt(0)
    v_mfma_f32_32x32x16_bf16 v[16:31], v[208:211], v[216:219], v[16:31]
L_concat_heads__ssm_conv_s4__grouped_kv_mqa__prompt_kernel_lw_29:
    ds_read_b32 v44, v10 offset:0
    s_waitcnt lgkmcnt(0)
    v_cmp_gt_u32 vcc, 2, v44
    s_cbranch_vccnz L_concat_heads__ssm_conv_s4__grouped_kv_mqa__prompt_kernel_lwr_30
    ds_read_b128 v[88:91], v32 offset:32768
    ds_read_b64_tr_b16 v[92:93], v40 offset:32768
    ds_read_b64_tr_b16 v[94:95], v40 offset:33280
    ds_read_b128 v[96:99], v33 offset:32768
    ds_read_b64_tr_b16 v[100:101], v40 offset:34816
    ds_read_b64_tr_b16 v[102:103], v40 offset:35328
    ds_read_b128 v[104:107], v34 offset:32768
    ds_read_b64_tr_b16 v[108:109], v40 offset:36864
    ds_read_b64_tr_b16 v[110:111], v40 offset:37376
    ds_read_b128 v[112:115], v35 offset:32768
    ds_read_b64_tr_b16 v[116:117], v40 offset:38912
    ds_read_b64_tr_b16 v[118:119], v40 offset:39424
    s_waitcnt lgkmcnt(9)
    v_mfma_f32_32x32x16_bf16 v[16:31], v[92:95], v[88:91], v[16:31]
    ds_read_b128 v[120:123], v36 offset:32768
    ds_read_b64_tr_b16 v[124:125], v40 offset:40960
    ds_read_b64_tr_b16 v[126:127], v40 offset:41472
    s_waitcnt lgkmcnt(9)
    v_mfma_f32_32x32x16_bf16 v[16:31], v[100:103], v[96:99], v[16:31]
    ds_read_b128 v[248:251], v37 offset:32768
    ds_read_b64_tr_b16 v[240:241], v40 offset:43008
    ds_read_b64_tr_b16 v[242:243], v40 offset:43520
    s_waitcnt lgkmcnt(9)
    v_mfma_f32_32x32x16_bf16 v[16:31], v[108:111], v[104:107], v[16:31]
    ds_read_b128 v[232:235], v38 offset:32768
    ds_read_b64_tr_b16 v[224:225], v40 offset:45056
    ds_read_b64_tr_b16 v[226:227], v40 offset:45568
    s_waitcnt lgkmcnt(9)
    v_mfma_f32_32x32x16_bf16 v[16:31], v[116:119], v[112:115], v[16:31]
    ds_read_b128 v[216:219], v39 offset:32768
    ds_read_b64_tr_b16 v[208:209], v40 offset:47104
    ds_read_b64_tr_b16 v[210:211], v40 offset:47616
    s_waitcnt lgkmcnt(9)
    v_mfma_f32_32x32x16_bf16 v[16:31], v[124:127], v[120:123], v[16:31]
    s_waitcnt lgkmcnt(6)
    v_mfma_f32_32x32x16_bf16 v[16:31], v[240:243], v[248:251], v[16:31]
    s_waitcnt lgkmcnt(3)
    v_mfma_f32_32x32x16_bf16 v[16:31], v[224:227], v[232:235], v[16:31]
    s_waitcnt lgkmcnt(0)
    v_mfma_f32_32x32x16_bf16 v[16:31], v[208:211], v[216:219], v[16:31]
    v_add_u32 v32, 0x10000, v32
    v_add_u32 v33, 0x10000, v33
    v_add_u32 v34, 0x10000, v34
    v_add_u32 v35, 0x10000, v35
    v_add_u32 v36, 0x10000, v36
    v_add_u32 v37, 0x10000, v37
    v_add_u32 v38, 0x10000, v38
    v_add_u32 v39, 0x10000, v39
    v_add_u32 v40, 0x10000, v40
L_concat_heads__ssm_conv_s4__grouped_kv_mqa__prompt_kernel_lw_31:
    ds_read_b32 v44, v10 offset:0
    s_waitcnt lgkmcnt(0)
    v_cmp_gt_u32 vcc, 3, v44
    s_cbranch_vccnz L_concat_heads__ssm_conv_s4__grouped_kv_mqa__prompt_kernel_lwr_32
    ds_read_b128 v[88:91], v32 offset:0
    ds_read_b64_tr_b16 v[92:93], v40 offset:0
    ds_read_b64_tr_b16 v[94:95], v40 offset:512
    ds_read_b128 v[96:99], v33 offset:0
    ds_read_b64_tr_b16 v[100:101], v40 offset:2048
    ds_read_b64_tr_b16 v[102:103], v40 offset:2560
    ds_read_b128 v[104:107], v34 offset:0
    ds_read_b64_tr_b16 v[108:109], v40 offset:4096
    ds_read_b64_tr_b16 v[110:111], v40 offset:4608
    ds_read_b128 v[112:115], v35 offset:0
    ds_read_b64_tr_b16 v[116:117], v40 offset:6144
    ds_read_b64_tr_b16 v[118:119], v40 offset:6656
    s_waitcnt lgkmcnt(9)
    v_mfma_f32_32x32x16_bf16 v[16:31], v[92:95], v[88:91], v[16:31]
    ds_read_b128 v[120:123], v36 offset:0
    ds_read_b64_tr_b16 v[124:125], v40 offset:8192
    ds_read_b64_tr_b16 v[126:127], v40 offset:8704
    s_waitcnt lgkmcnt(9)
    v_mfma_f32_32x32x16_bf16 v[16:31], v[100:103], v[96:99], v[16:31]
    ds_read_b128 v[248:251], v37 offset:0
    ds_read_b64_tr_b16 v[240:241], v40 offset:10240
    ds_read_b64_tr_b16 v[242:243], v40 offset:10752
    s_waitcnt lgkmcnt(9)
    v_mfma_f32_32x32x16_bf16 v[16:31], v[108:111], v[104:107], v[16:31]
    ds_read_b128 v[232:235], v38 offset:0
    ds_read_b64_tr_b16 v[224:225], v40 offset:12288
    ds_read_b64_tr_b16 v[226:227], v40 offset:12800
    s_waitcnt lgkmcnt(9)
    v_mfma_f32_32x32x16_bf16 v[16:31], v[116:119], v[112:115], v[16:31]
    ds_read_b128 v[216:219], v39 offset:0
    ds_read_b64_tr_b16 v[208:209], v40 offset:14336
    ds_read_b64_tr_b16 v[210:211], v40 offset:14848
    s_waitcnt lgkmcnt(9)
    v_mfma_f32_32x32x16_bf16 v[16:31], v[124:127], v[120:123], v[16:31]
    s_waitcnt lgkmcnt(6)
    v_mfma_f32_32x32x16_bf16 v[16:31], v[240:243], v[248:251], v[16:31]
    s_waitcnt lgkmcnt(3)
    v_mfma_f32_32x32x16_bf16 v[16:31], v[224:227], v[232:235], v[16:31]
    s_waitcnt lgkmcnt(0)
    v_mfma_f32_32x32x16_bf16 v[16:31], v[208:211], v[216:219], v[16:31]
L_concat_heads__ssm_conv_s4__grouped_kv_mqa__prompt_kernel_lw_33:
    ds_read_b32 v44, v10 offset:0
    s_waitcnt lgkmcnt(0)
    v_cmp_gt_u32 vcc, 4, v44
    s_cbranch_vccnz L_concat_heads__ssm_conv_s4__grouped_kv_mqa__prompt_kernel_lwr_34
    global_load_dwordx2 v[42:43], v49, s[48:49] sc1
    ds_read_b128 v[88:91], v32 offset:32768
    ds_read_b64_tr_b16 v[92:93], v40 offset:32768
    ds_read_b64_tr_b16 v[94:95], v40 offset:33280
    ds_read_b128 v[96:99], v33 offset:32768
    ds_read_b64_tr_b16 v[100:101], v40 offset:34816
    ds_read_b64_tr_b16 v[102:103], v40 offset:35328
    ds_read_b128 v[104:107], v34 offset:32768
    ds_read_b64_tr_b16 v[108:109], v40 offset:36864
    ds_read_b64_tr_b16 v[110:111], v40 offset:37376
    ds_read_b128 v[112:115], v35 offset:32768
    ds_read_b64_tr_b16 v[116:117], v40 offset:38912
    ds_read_b64_tr_b16 v[118:119], v40 offset:39424
    s_waitcnt lgkmcnt(9)
    v_mfma_f32_32x32x16_bf16 v[16:31], v[92:95], v[88:91], v[16:31]
    ds_read_b128 v[120:123], v36 offset:32768
    ds_read_b64_tr_b16 v[124:125], v40 offset:40960
    ds_read_b64_tr_b16 v[126:127], v40 offset:41472
    s_waitcnt lgkmcnt(9)
    v_mfma_f32_32x32x16_bf16 v[16:31], v[100:103], v[96:99], v[16:31]
    ds_read_b128 v[248:251], v37 offset:32768
    ds_read_b64_tr_b16 v[240:241], v40 offset:43008
    ds_read_b64_tr_b16 v[242:243], v40 offset:43520
    s_waitcnt lgkmcnt(9)
    v_mfma_f32_32x32x16_bf16 v[16:31], v[108:111], v[104:107], v[16:31]
    ds_read_b128 v[232:235], v38 offset:32768
    ds_read_b64_tr_b16 v[224:225], v40 offset:45056
    ds_read_b64_tr_b16 v[226:227], v40 offset:45568
    s_waitcnt lgkmcnt(9)
    v_mfma_f32_32x32x16_bf16 v[16:31], v[116:119], v[112:115], v[16:31]
    ds_read_b128 v[216:219], v39 offset:32768
    ds_read_b64_tr_b16 v[208:209], v40 offset:47104
    ds_read_b64_tr_b16 v[210:211], v40 offset:47616
    s_waitcnt lgkmcnt(9)
    v_mfma_f32_32x32x16_bf16 v[16:31], v[124:127], v[120:123], v[16:31]
    s_waitcnt lgkmcnt(6)
    v_mfma_f32_32x32x16_bf16 v[16:31], v[240:243], v[248:251], v[16:31]
    s_waitcnt lgkmcnt(3)
    v_mfma_f32_32x32x16_bf16 v[16:31], v[224:227], v[232:235], v[16:31]
    s_waitcnt lgkmcnt(0)
    v_mfma_f32_32x32x16_bf16 v[16:31], v[208:211], v[216:219], v[16:31]
    s_nop 11
    v_cvt_pk_bf16_f32 v32, v16, v17
    v_cvt_pk_bf16_f32 v33, v18, v19
    v_cvt_pk_bf16_f32 v34, v20, v21
    v_cvt_pk_bf16_f32 v35, v22, v23
    v_cvt_pk_bf16_f32 v36, v24, v25
    v_cvt_pk_bf16_f32 v37, v26, v27
    v_cvt_pk_bf16_f32 v38, v28, v29
    v_cvt_pk_bf16_f32 v39, v30, v31
    ds_write_b128 v48, v[32:35]
    ds_write_b128 v50, v[36:39]
    s_mov_b64 exec, 1
    ds_add_u32 v10, v9 offset:12
    s_mov_b64 exec, -1
L_kvchk:
    s_waitcnt vmcnt(0)
    v_cmp_ne_u64 vcc, s[50:51], v[42:43]
    s_cbranch_vccnz L_kvpoll
    global_load_dwordx4 v[64:67], v0, s[48:49] offset:-4096 sc1
    global_load_dwordx4 v[128:131], v3, s[48:49] offset:-4096 sc1
    global_load_dwordx4 v[68:71], v0, s[48:49] offset:-3072 sc1
    global_load_dwordx4 v[136:139], v3, s[48:49] offset:-3072 sc1
    global_load_dwordx4 v[72:75], v0, s[48:49] offset:-2048 sc1
    global_load_dwordx4 v[144:147], v3, s[48:49] offset:-2048 sc1
    global_load_dwordx4 v[76:79], v0, s[48:49] offset:-1024 sc1
    global_load_dwordx4 v[152:155], v3, s[48:49] offset:-1024 sc1
    global_load_dwordx4 v[80:83], v0, s[48:49] offset:0 sc1
    global_load_dwordx4 v[160:163], v3, s[48:49] offset:0 sc1
    global_load_dwordx4 v[84:87], v0, s[48:49] offset:1024 sc1
    global_load_dwordx4 v[168:171], v3, s[48:49] offset:1024 sc1
    v_mov_b64 v[16:17], 0
    v_mov_b64 v[18:19], 0
    v_mov_b64 v[20:21], 0
    v_mov_b64 v[22:23], 0
    v_mov_b64 v[24:25], 0
    v_mov_b64 v[26:27], 0
    v_mov_b64 v[28:29], 0
    v_mov_b64 v[30:31], 0
L_concat_heads__ssm_conv_s4__grouped_kv_mqa__prompt_kernel_lw_35:
    ds_read_b32 v44, v10 offset:12
    s_waitcnt lgkmcnt(0)
    v_cmp_gt_u32 vcc, 4, v44
    s_cbranch_vccnz L_concat_heads__ssm_conv_s4__grouped_kv_mqa__prompt_kernel_lwr_36
    ds_read_b128 v[12:15], v7
    s_setprio 0
    s_waitcnt vmcnt(11) lgkmcnt(0)
    v_mfma_f32_32x32x16_bf16 v[32:47], v[64:67], v[12:15], 0
    global_load_dwordx4 v[88:91], v0, s[48:49] offset:2048 sc1
    global_load_dwordx4 v[176:179], v3, s[48:49] offset:2048 sc1
    s_nop 9
    v_exp_f32 v32, v32
    v_exp_f32 v33, v33
    v_exp_f32 v34, v34
    v_exp_f32 v35, v35
    v_exp_f32 v36, v36
    s_waitcnt vmcnt(11)
    v_mfma_f32_32x32x16_bf16 v[48:63], v[68:71], v[12:15], 0
    v_permlane16_swap_b32 v128, v132
    v_permlane16_swap_b32 v129, v133
    v_permlane16_swap_b32 v130, v134
    v_permlane16_swap_b32 v131, v135
    v_exp_f32 v37, v37
    v_exp_f32 v38, v38
    v_exp_f32 v39, v39
    v_exp_f32 v40, v40
    v_exp_f32 v41, v41
    v_smfmac_f32_32x32x32_bf16 v[16:31], v[128:131], v[32:39], v11
    v_exp_f32 v42, v42
    v_exp_f32 v43, v43
    v_exp_f32 v44, v44
    v_exp_f32 v45, v45
    v_exp_f32 v46, v46
    v_exp_f32 v47, v47
    global_load_dwordx4 v[92:95], v0, s[48:49] offset:3072 sc1
    global_load_dwordx4 v[184:187], v3, s[48:49] offset:3072 sc1
    v_exp_f32 v48, v48
    v_exp_f32 v49, v49
    v_smfmac_f32_32x32x32_bf16 v[16:31], v[132:135], v[40:47], v11
    v_exp_f32 v50, v50
    v_exp_f32 v51, v51
    v_exp_f32 v52, v52
    s_waitcnt vmcnt(11)
    v_mfma_f32_32x32x16_bf16 v[32:47], v[72:75], v[12:15], 0
    v_permlane16_swap_b32 v136, v140
    v_permlane16_swap_b32 v137, v141
    v_permlane16_swap_b32 v138, v142
    v_permlane16_swap_b32 v139, v143
    v_exp_f32 v53, v53
    v_exp_f32 v54, v54
    v_exp_f32 v55, v55
    v_exp_f32 v56, v56
    v_exp_f32 v57, v57
    v_smfmac_f32_32x32x32_bf16 v[16:31], v[136:139], v[48:55], v11
    v_exp_f32 v58, v58
    v_exp_f32 v59, v59
    v_exp_f32 v60, v60
    v_exp_f32 v61, v61
    v_exp_f32 v62, v62
    v_exp_f32 v63, v63
    global_load_dwordx4 v[96:99], v4, s[48:49] offset:-4096 sc1
    global_load_dwordx4 v[192:195], v5, s[48:49] offset:-4096 sc1
    v_exp_f32 v32, v32
    v_exp_f32 v33, v33
    v_smfmac_f32_32x32x32_bf16 v[16:31], v[140:143], v[56:63], v11
    v_exp_f32 v34, v34
    v_exp_f32 v35, v35
    v_exp_f32 v36, v36
    s_waitcnt vmcnt(11)
    v_mfma_f32_32x32x16_bf16 v[48:63], v[76:79], v[12:15], 0
    v_permlane16_swap_b32 v144, v148
    v_permlane16_swap_b32 v145, v149
    v_permlane16_swap_b32 v146, v150
    v_permlane16_swap_b32 v147, v151
    v_exp_f32 v37, v37
    v_exp_f32 v38, v38
    v_exp_f32 v39, v39
    v_exp_f32 v40, v40
    v_exp_f32 v41, v41
    v_smfmac_f32_32x32x32_bf16 v[16:31], v[144:147], v[32:39], v11
    v_exp_f32 v42, v42
    v_exp_f32 v43, v43
    v_exp_f32 v44, v44
    v_exp_f32 v45, v45
    v_exp_f32 v46, v46
    v_exp_f32 v47, v47
    global_load_dwordx4 v[100:103], v4, s[48:49] offset:-3072 sc1
    global_load_dwordx4 v[200:203], v5, s[48:49] offset:-3072 sc1
    v_exp_f32 v48, v48
    v_exp_f32 v49, v49
    v_smfmac_f32_32x32x32_bf16 v[16:31], v[148:151], v[40:47], v11
    v_exp_f32 v50, v50
    v_exp_f32 v51, v51
    v_exp_f32 v52, v52
    s_waitcnt vmcnt(11)
    v_mfma_f32_32x32x16_bf16 v[32:47], v[80:83], v[12:15], 0
    v_permlane16_swap_b32 v152, v156
    v_permlane16_swap_b32 v153, v157
    v_permlane16_swap_b32 v154, v158
    v_permlane16_swap_b32 v155, v159
    v_exp_f32 v53, v53
    v_exp_f32 v54, v54
    v_exp_f32 v55, v55
    v_exp_f32 v56, v56
    v_exp_f32 v57, v57
    v_smfmac_f32_32x32x32_bf16 v[16:31], v[152:155], v[48:55], v11
    v_exp_f32 v58, v58
    v_exp_f32 v59, v59
    v_exp_f32 v60, v60
    v_exp_f32 v61, v61
    v_exp_f32 v62, v62
    v_exp_f32 v63, v63
    global_load_dwordx4 v[104:107], v4, s[48:49] offset:-2048 sc1
    global_load_dwordx4 v[208:211], v5, s[48:49] offset:-2048 sc1
    v_exp_f32 v32, v32
    v_exp_f32 v33, v33
    v_smfmac_f32_32x32x32_bf16 v[16:31], v[156:159], v[56:63], v11
    v_exp_f32 v34, v34
    v_exp_f32 v35, v35
    v_exp_f32 v36, v36
    s_waitcnt vmcnt(11)
    v_mfma_f32_32x32x16_bf16 v[48:63], v[84:87], v[12:15], 0
    v_permlane16_swap_b32 v160, v164
    v_permlane16_swap_b32 v161, v165
    v_permlane16_swap_b32 v162, v166
    v_permlane16_swap_b32 v163, v167
    v_exp_f32 v37, v37
    v_exp_f32 v38, v38
    v_exp_f32 v39, v39
    v_exp_f32 v40, v40
    v_exp_f32 v41, v41
    v_smfmac_f32_32x32x32_bf16 v[16:31], v[160:163], v[32:39], v11
    v_exp_f32 v42, v42
    v_exp_f32 v43, v43
    v_exp_f32 v44, v44
    v_exp_f32 v45, v45
    v_exp_f32 v46, v46
    v_exp_f32 v47, v47
    global_load_dwordx4 v[108:111], v4, s[48:49] offset:-1024 sc1
    global_load_dwordx4 v[216:219], v5, s[48:49] offset:-1024 sc1
    v_exp_f32 v48, v48
    v_exp_f32 v49, v49
    v_smfmac_f32_32x32x32_bf16 v[16:31], v[164:167], v[40:47], v11
    v_exp_f32 v50, v50
    v_exp_f32 v51, v51
    v_exp_f32 v52, v52
    s_waitcnt vmcnt(11)
    v_mfma_f32_32x32x16_bf16 v[32:47], v[88:91], v[12:15], 0
    v_permlane16_swap_b32 v168, v172
    v_permlane16_swap_b32 v169, v173
    v_permlane16_swap_b32 v170, v174
    v_permlane16_swap_b32 v171, v175
    v_exp_f32 v53, v53
    v_exp_f32 v54, v54
    v_exp_f32 v55, v55
    v_exp_f32 v56, v56
    v_exp_f32 v57, v57
    v_smfmac_f32_32x32x32_bf16 v[16:31], v[168:171], v[48:55], v11
    v_exp_f32 v58, v58
    v_exp_f32 v59, v59
    v_exp_f32 v60, v60
    v_exp_f32 v61, v61
    v_exp_f32 v62, v62
    v_exp_f32 v63, v63
    global_load_dwordx4 v[112:115], v4, s[48:49] offset:0 sc1
    global_load_dwordx4 v[224:227], v5, s[48:49] offset:0 sc1
    v_exp_f32 v32, v32
    v_exp_f32 v33, v33
    v_smfmac_f32_32x32x32_bf16 v[16:31], v[172:175], v[56:63], v11
    v_exp_f32 v34, v34
    v_exp_f32 v35, v35
    v_exp_f32 v36, v36
    s_waitcnt vmcnt(11)
    v_mfma_f32_32x32x16_bf16 v[48:63], v[92:95], v[12:15], 0
    v_permlane16_swap_b32 v176, v180
    v_permlane16_swap_b32 v177, v181
    v_permlane16_swap_b32 v178, v182
    v_permlane16_swap_b32 v179, v183
    v_exp_f32 v37, v37
    v_exp_f32 v38, v38
    v_exp_f32 v39, v39
    v_exp_f32 v40, v40
    v_exp_f32 v41, v41
    v_smfmac_f32_32x32x32_bf16 v[16:31], v[176:179], v[32:39], v11
    v_exp_f32 v42, v42
    v_exp_f32 v43, v43
    v_exp_f32 v44, v44
    v_exp_f32 v45, v45
    v_exp_f32 v46, v46
    v_exp_f32 v47, v47
    global_load_dwordx4 v[116:119], v4, s[48:49] offset:1024 sc1
    global_load_dwordx4 v[232:235], v5, s[48:49] offset:1024 sc1
    v_exp_f32 v48, v48
    v_exp_f32 v49, v49
    v_smfmac_f32_32x32x32_bf16 v[16:31], v[180:183], v[40:47], v11
    v_exp_f32 v50, v50
    v_exp_f32 v51, v51
    v_exp_f32 v52, v52
    s_waitcnt vmcnt(11)
    v_mfma_f32_32x32x16_bf16 v[32:47], v[96:99], v[12:15], 0
    v_permlane16_swap_b32 v184, v188
    v_permlane16_swap_b32 v185, v189
    v_permlane16_swap_b32 v186, v190
    v_permlane16_swap_b32 v187, v191
    v_exp_f32 v53, v53
    v_exp_f32 v54, v54
    v_exp_f32 v55, v55
    v_exp_f32 v56, v56
    v_exp_f32 v57, v57
    v_smfmac_f32_32x32x32_bf16 v[16:31], v[184:187], v[48:55], v11
    v_exp_f32 v58, v58
    v_exp_f32 v59, v59
    v_exp_f32 v60, v60
    v_exp_f32 v61, v61
    v_exp_f32 v62, v62
    v_exp_f32 v63, v63
    global_load_dwordx4 v[120:123], v4, s[48:49] offset:2048 sc1
    global_load_dwordx4 v[240:243], v5, s[48:49] offset:2048 sc1
    v_exp_f32 v32, v32
    v_exp_f32 v33, v33
    v_smfmac_f32_32x32x32_bf16 v[16:31], v[188:191], v[56:63], v11
    v_exp_f32 v34, v34
    v_exp_f32 v35, v35
    v_exp_f32 v36, v36
    s_waitcnt vmcnt(11)
    v_mfma_f32_32x32x16_bf16 v[48:63], v[100:103], v[12:15], 0
    v_permlane16_swap_b32 v192, v196
    v_permlane16_swap_b32 v193, v197
    v_permlane16_swap_b32 v194, v198
    v_permlane16_swap_b32 v195, v199
    v_exp_f32 v37, v37
    v_exp_f32 v38, v38
    v_exp_f32 v39, v39
    v_exp_f32 v40, v40
    v_exp_f32 v41, v41
    v_smfmac_f32_32x32x32_bf16 v[16:31], v[192:195], v[32:39], v11
    v_exp_f32 v42, v42
    v_exp_f32 v43, v43
    v_exp_f32 v44, v44
    v_exp_f32 v45, v45
    v_exp_f32 v46, v46
    v_exp_f32 v47, v47
    global_load_dwordx4 v[124:127], v4, s[48:49] offset:3072 sc1
    global_load_dwordx4 v[248:251], v5, s[48:49] offset:3072 sc1
    v_exp_f32 v48, v48
    v_exp_f32 v49, v49
    v_smfmac_f32_32x32x32_bf16 v[16:31], v[196:199], v[40:47], v11
    v_exp_f32 v50, v50
    v_exp_f32 v51, v51
    v_exp_f32 v52, v52
    s_waitcnt vmcnt(11)
    v_mfma_f32_32x32x16_bf16 v[32:47], v[104:107], v[12:15], 0
    v_permlane16_swap_b32 v200, v204
    v_permlane16_swap_b32 v201, v205
    v_permlane16_swap_b32 v202, v206
    v_permlane16_swap_b32 v203, v207
    v_exp_f32 v53, v53
    v_exp_f32 v54, v54
    v_exp_f32 v55, v55
    v_exp_f32 v56, v56
    v_exp_f32 v57, v57
    v_smfmac_f32_32x32x32_bf16 v[16:31], v[200:203], v[48:55], v11
    v_exp_f32 v58, v58
    v_exp_f32 v59, v59
    v_exp_f32 v60, v60
    v_exp_f32 v61, v61
    v_exp_f32 v62, v62
    v_exp_f32 v63, v63
    s_mov_b64 exec, 1
    ds_add_u32 v10, v9 offset:4
    s_mov_b64 exec, -1
    v_exp_f32 v32, v32
    v_exp_f32 v33, v33
    v_smfmac_f32_32x32x32_bf16 v[16:31], v[204:207], v[56:63], v11
    v_exp_f32 v34, v34
    v_exp_f32 v35, v35
    v_exp_f32 v36, v36
    s_waitcnt vmcnt(9)
    v_mfma_f32_32x32x16_bf16 v[48:63], v[108:111], v[12:15], 0
    v_permlane16_swap_b32 v208, v212
    v_permlane16_swap_b32 v209, v213
    v_permlane16_swap_b32 v210, v214
    v_permlane16_swap_b32 v211, v215
    v_exp_f32 v37, v37
    v_exp_f32 v38, v38
    v_exp_f32 v39, v39
    v_exp_f32 v40, v40
    v_exp_f32 v41, v41
    v_smfmac_f32_32x32x32_bf16 v[16:31], v[208:211], v[32:39], v11
    v_exp_f32 v42, v42
    v_exp_f32 v43, v43
    v_exp_f32 v44, v44
    v_exp_f32 v45, v45
    v_exp_f32 v46, v46
    v_exp_f32 v47, v47
    v_exp_f32 v48, v48
    v_exp_f32 v49, v49
    v_smfmac_f32_32x32x32_bf16 v[16:31], v[212:215], v[40:47], v11
    v_exp_f32 v50, v50
    v_exp_f32 v51, v51
    v_exp_f32 v52, v52
    s_waitcnt vmcnt(7)
    v_mfma_f32_32x32x16_bf16 v[32:47], v[112:115], v[12:15], 0
    v_permlane16_swap_b32 v216, v220
    v_permlane16_swap_b32 v217, v221
    v_permlane16_swap_b32 v218, v222
    v_permlane16_swap_b32 v219, v223
    v_exp_f32 v53, v53
    v_exp_f32 v54, v54
    v_exp_f32 v55, v55
    v_exp_f32 v56, v56
    v_exp_f32 v57, v57
    v_smfmac_f32_32x32x32_bf16 v[16:31], v[216:219], v[48:55], v11
    v_exp_f32 v58, v58
    v_exp_f32 v59, v59
    v_exp_f32 v60, v60
    v_exp_f32 v61, v61
    v_exp_f32 v62, v62
    v_exp_f32 v63, v63
    v_exp_f32 v32, v32
    v_exp_f32 v33, v33
    v_smfmac_f32_32x32x32_bf16 v[16:31], v[220:223], v[56:63], v11
    v_exp_f32 v34, v34
    v_exp_f32 v35, v35
    v_exp_f32 v36, v36
    s_waitcnt vmcnt(5)
    v_mfma_f32_32x32x16_bf16 v[48:63], v[116:119], v[12:15], 0
    v_permlane16_swap_b32 v224, v228
    v_permlane16_swap_b32 v225, v229
    v_permlane16_swap_b32 v226, v230
    v_permlane16_swap_b32 v227, v231
    v_exp_f32 v37, v37
    v_exp_f32 v38, v38
    v_exp_f32 v39, v39
    v_exp_f32 v40, v40
    v_exp_f32 v41, v41
    v_smfmac_f32_32x32x32_bf16 v[16:31], v[224:227], v[32:39], v11
    v_exp_f32 v42, v42
    v_exp_f32 v43, v43
    v_exp_f32 v44, v44
    v_exp_f32 v45, v45
    v_exp_f32 v46, v46
    v_exp_f32 v47, v47
    v_exp_f32 v48, v48
    v_exp_f32 v49, v49
    v_smfmac_f32_32x32x32_bf16 v[16:31], v[228:231], v[40:47], v11
    v_exp_f32 v50, v50
    v_exp_f32 v51, v51
    v_exp_f32 v52, v52
    s_waitcnt vmcnt(3)
    v_mfma_f32_32x32x16_bf16 v[32:47], v[120:123], v[12:15], 0
    v_permlane16_swap_b32 v232, v236
    v_permlane16_swap_b32 v233, v237
    v_permlane16_swap_b32 v234, v238
    v_permlane16_swap_b32 v235, v239
    v_exp_f32 v53, v53
    v_exp_f32 v54, v54
    v_exp_f32 v55, v55
    v_exp_f32 v56, v56
    v_exp_f32 v57, v57
    v_smfmac_f32_32x32x32_bf16 v[16:31], v[232:235], v[48:55], v11
    v_exp_f32 v58, v58
    v_exp_f32 v59, v59
    v_exp_f32 v60, v60
    v_exp_f32 v61, v61
    v_exp_f32 v62, v62
    v_exp_f32 v63, v63
    v_exp_f32 v32, v32
    v_exp_f32 v33, v33
    v_smfmac_f32_32x32x32_bf16 v[16:31], v[236:239], v[56:63], v11
    v_exp_f32 v34, v34
    v_exp_f32 v35, v35
    v_exp_f32 v36, v36
    s_waitcnt vmcnt(1)
    v_mfma_f32_32x32x16_bf16 v[48:63], v[124:127], v[12:15], 0
    v_add_u32 v7, 1024, v7
    ds_read_b128 v[12:15], v7
    v_permlane16_swap_b32 v240, v244
    v_permlane16_swap_b32 v241, v245
    v_permlane16_swap_b32 v242, v246
    v_permlane16_swap_b32 v243, v247
    v_exp_f32 v37, v37
    v_exp_f32 v38, v38
    v_exp_f32 v39, v39
    v_exp_f32 v40, v40
    v_exp_f32 v41, v41
    v_smfmac_f32_32x32x32_bf16 v[16:31], v[240:243], v[32:39], v11
    v_exp_f32 v42, v42
    v_exp_f32 v43, v43
    v_exp_f32 v44, v44
    v_exp_f32 v45, v45
    v_exp_f32 v46, v46
    v_exp_f32 v47, v47
    v_exp_f32 v48, v48
    v_exp_f32 v49, v49
    v_smfmac_f32_32x32x32_bf16 v[16:31], v[244:247], v[40:47], v11
    v_exp_f32 v50, v50
    v_exp_f32 v51, v51
    v_exp_f32 v52, v52
    s_waitcnt vmcnt(0)
    s_waitcnt lgkmcnt(0)
    v_mfma_f32_32x32x16_bf16 v[32:47], v[64:67], v[12:15], 0
    v_permlane16_swap_b32 v248, v252
    v_permlane16_swap_b32 v249, v253
    v_permlane16_swap_b32 v250, v254
    v_permlane16_swap_b32 v251, v255
    v_exp_f32 v53, v53
    v_exp_f32 v54, v54
    v_exp_f32 v55, v55
    v_exp_f32 v56, v56
    v_exp_f32 v57, v57
    v_smfmac_f32_32x32x32_bf16 v[16:31], v[248:251], v[48:55], v11
    v_exp_f32 v58, v58
    v_exp_f32 v59, v59
    v_exp_f32 v60, v60
    v_exp_f32 v61, v61
    v_exp_f32 v62, v62
    v_exp_f32 v63, v63
    s_mov_b32 s13, 7
    .p2align 6
L_aloop:
    v_exp_f32 v32, v32
    v_exp_f32 v33, v33
    v_smfmac_f32_32x32x32_bf16 v[16:31], v[252:255], v[56:63], v11
    v_exp_f32 v34, v34
    v_exp_f32 v35, v35
    v_exp_f32 v36, v36
    v_mfma_f32_32x32x16_bf16 v[48:63], v[68:71], v[12:15], 0
    v_exp_f32 v37, v37
    v_exp_f32 v38, v38
    v_exp_f32 v39, v39
    v_exp_f32 v40, v40
    v_exp_f32 v41, v41
    v_exp_f32 v42, v42
    v_exp_f32 v43, v43
    v_exp_f32 v44, v44
    ds_write_b128 v8, v[16:19] offset:0
    ds_write_b128 v8, v[20:23] offset:1024
    ds_write_b32 v2, v24 offset:2048
    ds_write_b32 v1, v9 offset:64
    v_mov_b64 v[16:17], 0
    v_mov_b64 v[18:19], 0
    v_mov_b64 v[20:21], 0
    v_mov_b64 v[22:23], 0
    v_mov_b64 v[24:25], 0
    v_exp_f32 v45, v45
    v_exp_f32 v46, v46
    v_smfmac_f32_32x32x32_bf16 v[16:31], v[128:131], v[32:39], v11
    v_exp_f32 v47, v47
    v_exp_f32 v48, v48
    v_exp_f32 v49, v49
    v_smfmac_f32_32x32x32_bf16 v[16:31], v[132:135], v[40:47], v11
    v_exp_f32 v50, v50
    v_exp_f32 v51, v51
    v_exp_f32 v52, v52
    v_mfma_f32_32x32x16_bf16 v[32:47], v[72:75], v[12:15], 0
    v_exp_f32 v53, v53
    v_exp_f32 v54, v54
    v_exp_f32 v55, v55
    v_exp_f32 v56, v56
    v_exp_f32 v57, v57
    v_smfmac_f32_32x32x32_bf16 v[16:31], v[136:139], v[48:55], v11
    v_exp_f32 v58, v58
    v_exp_f32 v59, v59
    v_exp_f32 v60, v60
    v_exp_f32 v61, v61
    v_exp_f32 v62, v62
    v_exp_f32 v63, v63
    v_add_u32 v8, 8704, v8
    v_add_u32 v2, 8704, v2
    v_add_u32 v1, 16, v1
    v_exp_f32 v32, v32
    v_exp_f32 v33, v33
    v_smfmac_f32_32x32x32_bf16 v[16:31], v[140:143], v[56:63], v11
    v_exp_f32 v34, v34
    v_exp_f32 v35, v35
    v_exp_f32 v36, v36
    v_mfma_f32_32x32x16_bf16 v[48:63], v[76:79], v[12:15], 0
    v_exp_f32 v37, v37
    v_exp_f32 v38, v38
    v_exp_f32 v39, v39
    v_exp_f32 v40, v40
    v_exp_f32 v41, v41
    v_smfmac_f32_32x32x32_bf16 v[16:31], v[144:147], v[32:39], v11
    v_exp_f32 v42, v42
    v_exp_f32 v43, v43
    v_exp_f32 v44, v44
    v_exp_f32 v45, v45
    v_exp_f32 v46, v46
    v_exp_f32 v47, v47
    v_exp_f32 v48, v48
    v_exp_f32 v49, v49
    v_smfmac_f32_32x32x32_bf16 v[16:31], v[148:151], v[40:47], v11
    v_exp_f32 v50, v50
    v_exp_f32 v51, v51
    v_exp_f32 v52, v52
    v_mfma_f32_32x32x16_bf16 v[32:47], v[80:83], v[12:15], 0
    v_exp_f32 v53, v53
    v_exp_f32 v54, v54
    v_exp_f32 v55, v55
    v_exp_f32 v56, v56
    v_exp_f32 v57, v57
    v_smfmac_f32_32x32x32_bf16 v[16:31], v[152:155], v[48:55], v11
    v_exp_f32 v58, v58
    v_exp_f32 v59, v59
    v_exp_f32 v60, v60
    v_exp_f32 v61, v61
    v_exp_f32 v62, v62
    v_exp_f32 v63, v63
    v_exp_f32 v32, v32
    v_exp_f32 v33, v33
    v_smfmac_f32_32x32x32_bf16 v[16:31], v[156:159], v[56:63], v11
    v_exp_f32 v34, v34
    v_exp_f32 v35, v35
    v_exp_f32 v36, v36
    v_mfma_f32_32x32x16_bf16 v[48:63], v[84:87], v[12:15], 0
    v_exp_f32 v37, v37
    v_exp_f32 v38, v38
    v_exp_f32 v39, v39
    v_exp_f32 v40, v40
    v_exp_f32 v41, v41
    v_smfmac_f32_32x32x32_bf16 v[16:31], v[160:163], v[32:39], v11
    v_exp_f32 v42, v42
    v_exp_f32 v43, v43
    v_exp_f32 v44, v44
    v_exp_f32 v45, v45
    v_exp_f32 v46, v46
    v_exp_f32 v47, v47
    v_exp_f32 v48, v48
    v_exp_f32 v49, v49
    v_smfmac_f32_32x32x32_bf16 v[16:31], v[164:167], v[40:47], v11
    v_exp_f32 v50, v50
    v_exp_f32 v51, v51
    v_exp_f32 v52, v52
    v_mfma_f32_32x32x16_bf16 v[32:47], v[88:91], v[12:15], 0
    v_exp_f32 v53, v53
    v_exp_f32 v54, v54
    v_exp_f32 v55, v55
    v_exp_f32 v56, v56
    v_exp_f32 v57, v57
    v_smfmac_f32_32x32x32_bf16 v[16:31], v[168:171], v[48:55], v11
    v_exp_f32 v58, v58
    v_exp_f32 v59, v59
    v_exp_f32 v60, v60
    v_exp_f32 v61, v61
    v_exp_f32 v62, v62
    v_exp_f32 v63, v63
    v_exp_f32 v32, v32
    v_exp_f32 v33, v33
    v_smfmac_f32_32x32x32_bf16 v[16:31], v[172:175], v[56:63], v11
    v_exp_f32 v34, v34
    v_exp_f32 v35, v35
    v_exp_f32 v36, v36
    v_mfma_f32_32x32x16_bf16 v[48:63], v[92:95], v[12:15], 0
    v_exp_f32 v37, v37
    v_exp_f32 v38, v38
    v_exp_f32 v39, v39
    v_exp_f32 v40, v40
    v_exp_f32 v41, v41
    v_smfmac_f32_32x32x32_bf16 v[16:31], v[176:179], v[32:39], v11
    v_exp_f32 v42, v42
    v_exp_f32 v43, v43
    v_exp_f32 v44, v44
    v_exp_f32 v45, v45
    v_exp_f32 v46, v46
    v_exp_f32 v47, v47
    v_exp_f32 v48, v48
    v_exp_f32 v49, v49
    v_smfmac_f32_32x32x32_bf16 v[16:31], v[180:183], v[40:47], v11
    v_exp_f32 v50, v50
    v_exp_f32 v51, v51
    v_exp_f32 v52, v52
    v_mfma_f32_32x32x16_bf16 v[32:47], v[96:99], v[12:15], 0
    v_exp_f32 v53, v53
    v_exp_f32 v54, v54
    v_exp_f32 v55, v55
    v_exp_f32 v56, v56
    v_exp_f32 v57, v57
    v_smfmac_f32_32x32x32_bf16 v[16:31], v[184:187], v[48:55], v11
    v_exp_f32 v58, v58
    v_exp_f32 v59, v59
    v_exp_f32 v60, v60
    v_exp_f32 v61, v61
    v_exp_f32 v62, v62
    v_exp_f32 v63, v63
    v_exp_f32 v32, v32
    v_exp_f32 v33, v33
    v_smfmac_f32_32x32x32_bf16 v[16:31], v[188:191], v[56:63], v11
    v_exp_f32 v34, v34
    v_exp_f32 v35, v35
    v_exp_f32 v36, v36
    v_mfma_f32_32x32x16_bf16 v[48:63], v[100:103], v[12:15], 0
    v_exp_f32 v37, v37
    v_exp_f32 v38, v38
    v_exp_f32 v39, v39
    v_exp_f32 v40, v40
    v_exp_f32 v41, v41
    v_smfmac_f32_32x32x32_bf16 v[16:31], v[192:195], v[32:39], v11
    v_exp_f32 v42, v42
    v_exp_f32 v43, v43
    v_exp_f32 v44, v44
    v_exp_f32 v45, v45
    v_exp_f32 v46, v46
    v_exp_f32 v47, v47
    v_exp_f32 v48, v48
    v_exp_f32 v49, v49
    v_smfmac_f32_32x32x32_bf16 v[16:31], v[196:199], v[40:47], v11
    v_exp_f32 v50, v50
    v_exp_f32 v51, v51
    v_exp_f32 v52, v52
    v_mfma_f32_32x32x16_bf16 v[32:47], v[104:107], v[12:15], 0
    v_exp_f32 v53, v53
    v_exp_f32 v54, v54
    v_exp_f32 v55, v55
    v_exp_f32 v56, v56
    v_exp_f32 v57, v57
    v_smfmac_f32_32x32x32_bf16 v[16:31], v[200:203], v[48:55], v11
    v_exp_f32 v58, v58
    v_exp_f32 v59, v59
    v_exp_f32 v60, v60
    v_exp_f32 v61, v61
    v_exp_f32 v62, v62
    v_exp_f32 v63, v63
    v_exp_f32 v32, v32
    v_exp_f32 v33, v33
    v_smfmac_f32_32x32x32_bf16 v[16:31], v[204:207], v[56:63], v11
    v_exp_f32 v34, v34
    v_exp_f32 v35, v35
    v_exp_f32 v36, v36
    v_mfma_f32_32x32x16_bf16 v[48:63], v[108:111], v[12:15], 0
    v_exp_f32 v37, v37
    v_exp_f32 v38, v38
    v_exp_f32 v39, v39
    v_exp_f32 v40, v40
    v_exp_f32 v41, v41
    v_smfmac_f32_32x32x32_bf16 v[16:31], v[208:211], v[32:39], v11
    v_exp_f32 v42, v42
    v_exp_f32 v43, v43
    v_exp_f32 v44, v44
    v_exp_f32 v45, v45
    v_exp_f32 v46, v46
    v_exp_f32 v47, v47
    v_exp_f32 v48, v48
    v_exp_f32 v49, v49
    v_smfmac_f32_32x32x32_bf16 v[16:31], v[212:215], v[40:47], v11
    v_exp_f32 v50, v50
    v_exp_f32 v51, v51
    v_exp_f32 v52, v52
    v_mfma_f32_32x32x16_bf16 v[32:47], v[112:115], v[12:15], 0
    v_exp_f32 v53, v53
    v_exp_f32 v54, v54
    v_exp_f32 v55, v55
    v_exp_f32 v56, v56
    v_exp_f32 v57, v57
    v_smfmac_f32_32x32x32_bf16 v[16:31], v[216:219], v[48:55], v11
    v_exp_f32 v58, v58
    v_exp_f32 v59, v59
    v_exp_f32 v60, v60
    v_exp_f32 v61, v61
    v_exp_f32 v62, v62
    v_exp_f32 v63, v63
    v_exp_f32 v32, v32
    v_exp_f32 v33, v33
    v_smfmac_f32_32x32x32_bf16 v[16:31], v[220:223], v[56:63], v11
    v_exp_f32 v34, v34
    v_exp_f32 v35, v35
    v_exp_f32 v36, v36
    v_mfma_f32_32x32x16_bf16 v[48:63], v[116:119], v[12:15], 0
    v_exp_f32 v37, v37
    v_exp_f32 v38, v38
    v_exp_f32 v39, v39
    v_exp_f32 v40, v40
    v_exp_f32 v41, v41
    v_smfmac_f32_32x32x32_bf16 v[16:31], v[224:227], v[32:39], v11
    v_exp_f32 v42, v42
    v_exp_f32 v43, v43
    v_exp_f32 v44, v44
    v_exp_f32 v45, v45
    v_exp_f32 v46, v46
    v_exp_f32 v47, v47
    v_exp_f32 v48, v48
    v_exp_f32 v49, v49
    v_smfmac_f32_32x32x32_bf16 v[16:31], v[228:231], v[40:47], v11
    v_exp_f32 v50, v50
    v_exp_f32 v51, v51
    v_exp_f32 v52, v52
    v_mfma_f32_32x32x16_bf16 v[32:47], v[120:123], v[12:15], 0
    v_exp_f32 v53, v53
    v_exp_f32 v54, v54
    v_exp_f32 v55, v55
    v_exp_f32 v56, v56
    v_exp_f32 v57, v57
    v_smfmac_f32_32x32x32_bf16 v[16:31], v[232:235], v[48:55], v11
    v_exp_f32 v58, v58
    v_exp_f32 v59, v59
    v_exp_f32 v60, v60
    v_exp_f32 v61, v61
    v_exp_f32 v62, v62
    v_exp_f32 v63, v63
    v_exp_f32 v32, v32
    v_exp_f32 v33, v33
    v_smfmac_f32_32x32x32_bf16 v[16:31], v[236:239], v[56:63], v11
    v_exp_f32 v34, v34
    v_exp_f32 v35, v35
    v_exp_f32 v36, v36
    v_mfma_f32_32x32x16_bf16 v[48:63], v[124:127], v[12:15], 0
    v_add_u32 v7, 1024, v7
    ds_read_b128 v[12:15], v7
    v_exp_f32 v37, v37
    v_exp_f32 v38, v38
    v_exp_f32 v39, v39
    v_exp_f32 v40, v40
    v_exp_f32 v41, v41
    v_smfmac_f32_32x32x32_bf16 v[16:31], v[240:243], v[32:39], v11
    v_exp_f32 v42, v42
    v_exp_f32 v43, v43
    v_exp_f32 v44, v44
    v_exp_f32 v45, v45
    v_exp_f32 v46, v46
    v_exp_f32 v47, v47
    v_exp_f32 v48, v48
    v_exp_f32 v49, v49
    v_smfmac_f32_32x32x32_bf16 v[16:31], v[244:247], v[40:47], v11
    v_exp_f32 v50, v50
    v_exp_f32 v51, v51
    v_exp_f32 v52, v52
    s_waitcnt lgkmcnt(0)
    v_mfma_f32_32x32x16_bf16 v[32:47], v[64:67], v[12:15], 0
    v_exp_f32 v53, v53
    v_exp_f32 v54, v54
    v_exp_f32 v55, v55
    v_exp_f32 v56, v56
    v_exp_f32 v57, v57
    v_smfmac_f32_32x32x32_bf16 v[16:31], v[248:251], v[48:55], v11
    v_exp_f32 v58, v58
    v_exp_f32 v59, v59
    v_exp_f32 v60, v60
    v_exp_f32 v61, v61
    v_exp_f32 v62, v62
    v_exp_f32 v63, v63
    s_sub_u32 s13, s13, 1
    s_cmp_lg_u32 s13, 0
    s_cbranch_scc1 L_aloop
    v_smfmac_f32_32x32x32_bf16 v[16:31], v[252:255], v[56:63], v11
    s_setprio 3
    v_bfe_u32 v64, v6, 4, 2
    v_lshl_add_u32 v64, v64, 2, v10
    v_add_u32 v65, 60928, v6
    v_bfe_u32 v66, v6, 4, 5
    v_lshlrev_b32 v66, 2, v66
    v_add_u32 v66, 60928, v66
    s_lshl1_add_u32 s10, s6, 1
    s_lshl_b32 s10, s10, 14
    s_lshl_b32 s11, s7, 11
    s_add_u32 s10, s10, s11
    s_add_u32 s10, s10, 10485760
    v_bfe_u32 v3, v6, 4, 4
    v_lshrrev_b32 v5, 9, v6
    s_mov_b32 s57, 7
    ds_write_b128 v8, v[16:19] offset:0
    ds_write_b128 v8, v[20:23] offset:1024
    ds_write_b32 v2, v24 offset:2048
    ds_write_b32 v1, v9 offset:64
    ds_read_b32 v67, v64 offset:176
    ds_read_b128 v[72:75], v65 offset:0
    ds_read_b128 v[76:79], v65 offset:1024
    ds_read_b32 v68, v66 offset:2048
    ds_read_b128 v[80:83], v65 offset:2176
    ds_read_b128 v[84:87], v65 offset:3200
    ds_read_b32 v69, v66 offset:4224
    ds_read_b128 v[88:91], v65 offset:4352
    ds_read_b128 v[92:95], v65 offset:5376
    ds_read_b32 v70, v66 offset:6400
    ds_read_b128 v[96:99], v65 offset:6528
    ds_read_b128 v[100:103], v65 offset:7552
    ds_read_b32 v71, v66 offset:8576
    v_add_u32 v254, s10, v6
    v_mov_b32 v244, s50
    v_mov_b32 v245, s51
    v_mov_b32 v104, s50
    v_mov_b32 v105, s51
    v_mov_b32 v110, s50
    v_mov_b32 v111, s51
    v_xor_b32 v112, 1048576, v254
    s_mov_b32 s10, 0x21800000
    s_mov_b32 s11, 0x3c000000
    s_waitcnt lgkmcnt(12)
    v_cmp_gt_u32 vcc, 1, v67
    s_cbranch_vccnz L_end
    s_waitcnt lgkmcnt(6)
    v_add_f32 v72, v72, v80
    v_add_f32 v73, v73, v81
    v_add_f32 v74, v74, v82
    v_add_f32 v75, v75, v83
    v_add_f32 v76, v76, v84
    v_add_f32 v77, v77, v85
    v_add_f32 v78, v78, v86
    v_add_f32 v79, v79, v87
    v_add_f32 v68, v68, v69
    s_waitcnt lgkmcnt(0)
    v_add_f32 v70, v70, v71
    v_add_f32 v88, v88, v96
    v_add_f32 v89, v89, v97
    v_add_f32 v90, v90, v98
    v_add_f32 v91, v91, v99
    v_add_f32 v92, v92, v100
    v_add_f32 v93, v93, v101
    v_add_f32 v94, v94, v102
    v_add_f32 v95, v95, v103
    v_add_f32 v68, v68, v70
    v_rcp_f32 v69, v68
    v_subrev_u32 v70, s10, v68
    v_cmp_lt_u32 vcc, s11, v70
    v_add_f32 v72, v72, v88
    v_add_f32 v73, v73, v89
    v_add_f32 v74, v74, v90
    v_add_f32 v75, v75, v91
    v_add_f32 v76, v76, v92
    v_add_f32 v77, v77, v93
    v_add_f32 v78, v78, v94
    v_add_f32 v79, v79, v95
    s_cbranch_vccnz L_red7slow
    v_mul_f32 v72, v72, v69
    v_mul_f32 v73, v73, v69
    v_mul_f32 v74, v74, v69
    v_mul_f32 v75, v75, v69
    v_mul_f32 v76, v76, v69
    v_mul_f32 v77, v77, v69
    v_mul_f32 v78, v78, v69
    v_mul_f32 v79, v79, v69
    v_cvt_pk_bf16_f32 v106, v72, v73
    v_cvt_pk_bf16_f32 v107, v74, v75
    v_cvt_pk_bf16_f32 v108, v76, v77
    v_cvt_pk_bf16_f32 v109, v78, v79
    global_store_dwordx4 v254, v[104:107], s[48:49]
    global_store_dwordx4 v254, v[108:111], s[48:49] offset:1024
    global_store_dwordx4 v112, v[104:107], s[48:49] sc1
    global_store_dwordx4 v112, v[108:111], s[48:49] offset:1024 sc1
L_red7done:
    s_cmp_lg_u32 s2, 0
    s_cbranch_scc1 L_end
    v_mov_b32 v14, 131072
    s_mov_b64 exec, 1
    global_store_dwordx2 v14, v[244:245], s[48:49]
    s_mov_b64 exec, -1
L_end:
L_exit:
    s_endpgm
L_concat_heads__ssm_conv_s4__grouped_kv_mqa__prompt_kernel_lwr_2:
    s_sub_u32 s63, s63, 1
    s_cbranch_scc1 L_end
    s_sleep 1
    s_branch L_concat_heads__ssm_conv_s4__grouped_kv_mqa__prompt_kernel_lw_1
L_concat_heads__ssm_conv_s4__grouped_kv_mqa__prompt_kernel_lwr_4:
    s_sub_u32 s63, s63, 1
    s_cbranch_scc1 L_end
    s_sleep 2
    s_branch L_concat_heads__ssm_conv_s4__grouped_kv_mqa__prompt_kernel_lw_3
L_concat_heads__ssm_conv_s4__grouped_kv_mqa__prompt_kernel_lwr_6:
    s_sub_u32 s63, s63, 1
    s_cbranch_scc1 L_end
    s_sleep 4
    s_branch L_concat_heads__ssm_conv_s4__grouped_kv_mqa__prompt_kernel_lw_5
L_concat_heads__ssm_conv_s4__grouped_kv_mqa__prompt_kernel_gpr_8:
    s_sub_u32 s63, s63, 1
    s_cbranch_scc1 L_end
    s_sleep 8
    s_branch L_concat_heads__ssm_conv_s4__grouped_kv_mqa__prompt_kernel_gp_7
L_concat_heads__ssm_conv_s4__grouped_kv_mqa__prompt_kernel_lwr_10:
    s_sub_u32 s63, s63, 1
    s_cbranch_scc1 L_end
    s_sleep 3
    s_branch L_concat_heads__ssm_conv_s4__grouped_kv_mqa__prompt_kernel_lw_9
L_concat_heads__ssm_conv_s4__grouped_kv_mqa__prompt_kernel_lwr_12:
    s_sub_u32 s63, s63, 1
    s_cbranch_scc1 L_end
    s_sleep 3
    s_branch L_concat_heads__ssm_conv_s4__grouped_kv_mqa__prompt_kernel_lw_11
L_concat_heads__ssm_conv_s4__grouped_kv_mqa__prompt_kernel_lwr_14:
    s_sub_u32 s63, s63, 1
    s_cbranch_scc1 L_end
    s_sleep 2
    s_branch L_concat_heads__ssm_conv_s4__grouped_kv_mqa__prompt_kernel_lw_13
L_concat_heads__ssm_conv_s4__grouped_kv_mqa__prompt_kernel_gpr_16:
    s_sub_u32 s63, s63, 1
    s_cbranch_scc1 L_end
    s_sleep 8
    s_branch L_concat_heads__ssm_conv_s4__grouped_kv_mqa__prompt_kernel_gp_15
L_concat_heads__ssm_conv_s4__grouped_kv_mqa__prompt_kernel_gpr_18:
    s_sub_u32 s63, s63, 1
    s_cbranch_scc1 L_end
    s_sleep 10
    s_branch L_concat_heads__ssm_conv_s4__grouped_kv_mqa__prompt_kernel_gp_17
L_concat_heads__ssm_conv_s4__grouped_kv_mqa__prompt_kernel_lwr_20:
    s_sub_u32 s63, s63, 1
    s_cbranch_scc1 L_end
    s_sleep 2
    s_branch L_concat_heads__ssm_conv_s4__grouped_kv_mqa__prompt_kernel_lw_19
L_concat_heads__ssm_conv_s4__grouped_kv_mqa__prompt_kernel_lwr_22:
    s_sub_u32 s63, s63, 1
    s_cbranch_scc1 L_end
    s_sleep 4
    s_branch L_concat_heads__ssm_conv_s4__grouped_kv_mqa__prompt_kernel_lw_21
L_concat_heads__ssm_conv_s4__grouped_kv_mqa__prompt_kernel_lwr_24:
    s_sub_u32 s63, s63, 1
    s_cbranch_scc1 L_end
    s_sleep 2
    s_branch L_concat_heads__ssm_conv_s4__grouped_kv_mqa__prompt_kernel_lw_23
L_tr0:
    s_sub_u32 s63, s63, 1
    s_cbranch_scc1 L_end
    s_add_u32 s56, s56, 1
    s_cmp_lt_u32 s56, 24
    s_cbranch_scc1 L_tq0
    v_xor_b32 v253, 1048576, v253
    v_xor_b32 v24, 1048576, v24
    s_sleep 2
L_tq0:
    s_waitcnt vmcnt(0)
    global_load_dwordx4 v[164:167], v253, s[48:49] offset:-4096 sc1
    global_load_dwordx4 v[168:171], v253, s[48:49] offset:-3072 sc1
    global_load_dwordx4 v[172:175], v253, s[48:49] offset:-2048 sc1
    global_load_dwordx4 v[176:179], v253, s[48:49] offset:-1024 sc1
    global_load_dwordx4 v[180:183], v253, s[48:49] offset:0 sc1
    global_load_dwordx4 v[184:187], v253, s[48:49] offset:1024 sc1
    global_load_dwordx4 v[188:191], v253, s[48:49] offset:2048 sc1
    global_load_dwordx4 v[192:195], v253, s[48:49] offset:3072 sc1
    global_load_dwordx4 v[196:199], v24, s[48:49] offset:-4096 sc1
    global_load_dwordx4 v[200:203], v24, s[48:49] offset:-3072 sc1
    global_load_dwordx4 v[204:207], v24, s[48:49] offset:-2048 sc1
    global_load_dwordx4 v[208:211], v24, s[48:49] offset:-1024 sc1
    global_load_dwordx4 v[212:215], v24, s[48:49] offset:0 sc1
    global_load_dwordx4 v[216:219], v24, s[48:49] offset:1024 sc1
    global_load_dwordx4 v[220:223], v24, s[48:49] offset:2048 sc1
    global_load_dwordx4 v[224:227], v24, s[48:49] offset:3072 sc1
    s_branch L_tc0
L_tr1:
    s_sub_u32 s63, s63, 1
    s_cbranch_scc1 L_end
    s_add_u32 s56, s56, 1
    s_cmp_lt_u32 s56, 24
    s_cbranch_scc1 L_tq1
    v_xor_b32 v253, 1048576, v253
    v_xor_b32 v24, 1048576, v24
    s_sleep 2
L_tq1:
    s_waitcnt vmcnt(0)
    global_load_dwordx4 v[172:175], v253, s[48:49] offset:-2048 sc1
    global_load_dwordx4 v[176:179], v253, s[48:49] offset:-1024 sc1
    global_load_dwordx4 v[180:183], v253, s[48:49] offset:0 sc1
    global_load_dwordx4 v[184:187], v253, s[48:49] offset:1024 sc1
    global_load_dwordx4 v[188:191], v253, s[48:49] offset:2048 sc1
    global_load_dwordx4 v[192:195], v253, s[48:49] offset:3072 sc1
    global_load_dwordx4 v[196:199], v24, s[48:49] offset:-4096 sc1
    global_load_dwordx4 v[200:203], v24, s[48:49] offset:-3072 sc1
    global_load_dwordx4 v[204:207], v24, s[48:49] offset:-2048 sc1
    global_load_dwordx4 v[208:211], v24, s[48:49] offset:-1024 sc1
    global_load_dwordx4 v[212:215], v24, s[48:49] offset:0 sc1
    global_load_dwordx4 v[216:219], v24, s[48:49] offset:1024 sc1
    global_load_dwordx4 v[220:223], v24, s[48:49] offset:2048 sc1
    global_load_dwordx4 v[224:227], v24, s[48:49] offset:3072 sc1
    s_branch L_tc1
L_tr2:
    s_sub_u32 s63, s63, 1
    s_cbranch_scc1 L_end
    s_add_u32 s56, s56, 1
    s_cmp_lt_u32 s56, 24
    s_cbranch_scc1 L_tq2
    v_xor_b32 v253, 1048576, v253
    v_xor_b32 v24, 1048576, v24
    s_sleep 2
L_tq2:
    s_waitcnt vmcnt(0)
    global_load_dwordx4 v[180:183], v253, s[48:49] offset:0 sc1
    global_load_dwordx4 v[184:187], v253, s[48:49] offset:1024 sc1
    global_load_dwordx4 v[188:191], v253, s[48:49] offset:2048 sc1
    global_load_dwordx4 v[192:195], v253, s[48:49] offset:3072 sc1
    global_load_dwordx4 v[196:199], v24, s[48:49] offset:-4096 sc1
    global_load_dwordx4 v[200:203], v24, s[48:49] offset:-3072 sc1
    global_load_dwordx4 v[204:207], v24, s[48:49] offset:-2048 sc1
    global_load_dwordx4 v[208:211], v24, s[48:49] offset:-1024 sc1
    global_load_dwordx4 v[212:215], v24, s[48:49] offset:0 sc1
    global_load_dwordx4 v[216:219], v24, s[48:49] offset:1024 sc1
    global_load_dwordx4 v[220:223], v24, s[48:49] offset:2048 sc1
    global_load_dwordx4 v[224:227], v24, s[48:49] offset:3072 sc1
    s_branch L_tc2
L_tr3:
    s_sub_u32 s63, s63, 1
    s_cbranch_scc1 L_end
    s_add_u32 s56, s56, 1
    s_cmp_lt_u32 s56, 24
    s_cbranch_scc1 L_tq3
    v_xor_b32 v253, 1048576, v253
    v_xor_b32 v24, 1048576, v24
    s_sleep 2
L_tq3:
    s_waitcnt vmcnt(0)
    global_load_dwordx4 v[188:191], v253, s[48:49] offset:2048 sc1
    global_load_dwordx4 v[192:195], v253, s[48:49] offset:3072 sc1
    global_load_dwordx4 v[196:199], v24, s[48:49] offset:-4096 sc1
    global_load_dwordx4 v[200:203], v24, s[48:49] offset:-3072 sc1
    global_load_dwordx4 v[204:207], v24, s[48:49] offset:-2048 sc1
    global_load_dwordx4 v[208:211], v24, s[48:49] offset:-1024 sc1
    global_load_dwordx4 v[212:215], v24, s[48:49] offset:0 sc1
    global_load_dwordx4 v[216:219], v24, s[48:49] offset:1024 sc1
    global_load_dwordx4 v[220:223], v24, s[48:49] offset:2048 sc1
    global_load_dwordx4 v[224:227], v24, s[48:49] offset:3072 sc1
    s_branch L_tc3
L_tr4:
    s_sub_u32 s63, s63, 1
    s_cbranch_scc1 L_end
    s_add_u32 s56, s56, 1
    s_cmp_lt_u32 s56, 24
    s_cbranch_scc1 L_tq4
    v_xor_b32 v253, 1048576, v253
    v_xor_b32 v24, 1048576, v24
    s_sleep 2
L_tq4:
    s_waitcnt vmcnt(0)
    global_load_dwordx4 v[196:199], v24, s[48:49] offset:-4096 sc1
    global_load_dwordx4 v[200:203], v24, s[48:49] offset:-3072 sc1
    global_load_dwordx4 v[204:207], v24, s[48:49] offset:-2048 sc1
    global_load_dwordx4 v[208:211], v24, s[48:49] offset:-1024 sc1
    global_load_dwordx4 v[212:215], v24, s[48:49] offset:0 sc1
    global_load_dwordx4 v[216:219], v24, s[48:49] offset:1024 sc1
    global_load_dwordx4 v[220:223], v24, s[48:49] offset:2048 sc1
    global_load_dwordx4 v[224:227], v24, s[48:49] offset:3072 sc1
    s_branch L_tc4
L_tr5:
    s_sub_u32 s63, s63, 1
    s_cbranch_scc1 L_end
    s_add_u32 s56, s56, 1
    s_cmp_lt_u32 s56, 24
    s_cbranch_scc1 L_tq5
    v_xor_b32 v253, 1048576, v253
    v_xor_b32 v24, 1048576, v24
    s_sleep 2
L_tq5:
    s_waitcnt vmcnt(0)
    global_load_dwordx4 v[204:207], v24, s[48:49] offset:-2048 sc1
    global_load_dwordx4 v[208:211], v24, s[48:49] offset:-1024 sc1
    global_load_dwordx4 v[212:215], v24, s[48:49] offset:0 sc1
    global_load_dwordx4 v[216:219], v24, s[48:49] offset:1024 sc1
    global_load_dwordx4 v[220:223], v24, s[48:49] offset:2048 sc1
    global_load_dwordx4 v[224:227], v24, s[48:49] offset:3072 sc1
    s_branch L_tc5
L_tr6:
    s_sub_u32 s63, s63, 1
    s_cbranch_scc1 L_end
    s_add_u32 s56, s56, 1
    s_cmp_lt_u32 s56, 24
    s_cbranch_scc1 L_tq6
    v_xor_b32 v253, 1048576, v253
    v_xor_b32 v24, 1048576, v24
    s_sleep 2
L_tq6:
    s_waitcnt vmcnt(0)
    global_load_dwordx4 v[212:215], v24, s[48:49] offset:0 sc1
    global_load_dwordx4 v[216:219], v24, s[48:49] offset:1024 sc1
    global_load_dwordx4 v[220:223], v24, s[48:49] offset:2048 sc1
    global_load_dwordx4 v[224:227], v24, s[48:49] offset:3072 sc1
    s_branch L_tc6
L_tr7:
    s_sub_u32 s63, s63, 1
    s_cbranch_scc1 L_end
    s_add_u32 s56, s56, 1
    s_cmp_lt_u32 s56, 24
    s_cbranch_scc1 L_tq7
    v_xor_b32 v253, 1048576, v253
    v_xor_b32 v24, 1048576, v24
    s_sleep 2
L_tq7:
    s_waitcnt vmcnt(0)
    global_load_dwordx4 v[220:223], v24, s[48:49] offset:2048 sc1
    global_load_dwordx4 v[224:227], v24, s[48:49] offset:3072 sc1
    s_branch L_tc7
L_tprer:
    s_sub_u32 s63, s63, 1
    s_cbranch_scc1 L_end
    s_add_u32 s56, s56, 1
    s_cmp_lt_u32 s56, 24
    s_cbranch_scc1 L_tpre
    v_xor_b32 v255, 1048576, v255
    v_xor_b32 v253, 1048576, v253
    s_sleep 2
    s_branch L_tpre
L_concat_heads__ssm_conv_s4__grouped_kv_mqa__prompt_kernel_lwr_26:
    s_sub_u32 s63, s63, 1
    s_cbranch_scc1 L_end
    s_sleep 3
    s_branch L_concat_heads__ssm_conv_s4__grouped_kv_mqa__prompt_kernel_lw_25
L_concat_heads__ssm_conv_s4__grouped_kv_mqa__prompt_kernel_lwr_28:
    s_sub_u32 s63, s63, 1
    s_cbranch_scc1 L_end
    s_sleep 1
    s_branch L_concat_heads__ssm_conv_s4__grouped_kv_mqa__prompt_kernel_lw_27
L_concat_heads__ssm_conv_s4__grouped_kv_mqa__prompt_kernel_lwr_30:
    s_sub_u32 s63, s63, 1
    s_cbranch_scc1 L_end
    s_sleep 1
    s_branch L_concat_heads__ssm_conv_s4__grouped_kv_mqa__prompt_kernel_lw_29
L_concat_heads__ssm_conv_s4__grouped_kv_mqa__prompt_kernel_lwr_32:
    s_sub_u32 s63, s63, 1
    s_cbranch_scc1 L_end
    s_sleep 1
    s_branch L_concat_heads__ssm_conv_s4__grouped_kv_mqa__prompt_kernel_lw_31
L_concat_heads__ssm_conv_s4__grouped_kv_mqa__prompt_kernel_lwr_34:
    s_sub_u32 s63, s63, 1
    s_cbranch_scc1 L_end
    s_sleep 1
    s_branch L_concat_heads__ssm_conv_s4__grouped_kv_mqa__prompt_kernel_lw_33
L_kvpoll:
    s_sub_u32 s63, s63, 1
    s_cbranch_scc1 L_end
    s_sleep 8
    global_load_dwordx2 v[42:43], v49, s[48:49] sc1
    s_branch L_kvchk
L_concat_heads__ssm_conv_s4__grouped_kv_mqa__prompt_kernel_lwr_36:
    s_sub_u32 s63, s63, 1
    s_cbranch_scc1 L_end
    s_sleep 1
    s_branch L_concat_heads__ssm_conv_s4__grouped_kv_mqa__prompt_kernel_lw_35
L_red7slow:
    v_mov_b32 v25, v65
    v_mov_b32 v26, v66
    v_mov_b32 v27, v6
    v_mov_b32 v28, v6
    s_call_b64 s[64:65], L_red2
    s_branch L_red7done
L_codeend:
    s_endpgm
.section .rodata,"a"
.p2align 6
.amdhsa_kernel concat_heads__ssm_conv_s4__grouped_kv_mqa__prompt_kernel
  .amdhsa_next_free_vgpr 256
  .amdhsa_next_free_sgpr 66
  .amdhsa_accum_offset 256
  .amdhsa_group_segment_fixed_size 0
  .amdhsa_kernarg_size 136
  .amdhsa_user_sgpr_count 2
  .amdhsa_user_sgpr_kernarg_segment_ptr 1
  .amdhsa_system_sgpr_workgroup_id_x 1
.end_amdhsa_kernel
```
